```python
import torch

def _softmax(x, axis=-1):
    return torch.softmax(x, dim=axis)
def _gelu(x):
    return torch.nn.functional.gelu(x, approximate="tanh")
def _silu(x):
    return torch.nn.functional.silu(x)
def _sigmoid(x):
    return torch.sigmoid(x)
def _layernorm(x, axis=-1, eps=1e-5):
    m = x.mean(dim=axis, keepdim=True)
    v = x.var(dim=axis, keepdim=True, unbiased=False)
    return (x - m) / torch.sqrt(v + eps)
def _scatter_add(tgt, idx, src, axis=0):
    return tgt.clone().index_add_(axis, idx, src)
def _segment_sum(src, seg, n):
    out = torch.zeros((n,) + src.shape[1:], dtype=src.dtype)
    return out.index_add_(0, seg, src)
def _pad(x, pw):
    flat = tuple(v for pair in reversed(pw) for v in pair)
    return torch.nn.functional.pad(x, flat)

kernel_name = 'concat_heads__compressed_kv_cla__mha_block_cached__decode'

def setup_inputs():

    _w = (lambda a: (lambda t: t.to(torch.bfloat16) if t.is_floating_point() else t)(torch.as_tensor(a)))
    def _A_setup():
        B, H, Sq, Sk, D, M = 1, 32, 1, 8192, 128, 512
        Dc = 4 * D
        return {
            "x": _w((lambda *s: torch.randn(*s, dtype=torch.bfloat16) * 3.2)(B, Sq, M)),
            "c_kv": _w((lambda *s: torch.randn(*s, dtype=torch.bfloat16) * 0.1)(B, Sk, Dc)),
            "w_q": _w((lambda *s: torch.randn(*s, dtype=torch.bfloat16) * 6.4)(M, H, D) * (M ** -0.5)),
            "w_uk": _w((lambda *s: torch.randn(*s, dtype=torch.bfloat16) * 6.4)(Dc, H, D) * (Dc ** -0.5)),
            "w_uv": _w((lambda *s: torch.randn(*s, dtype=torch.bfloat16) * 0.1)(Dc, H, D) * (Dc ** -0.5)),
            "w_o": _w((lambda *s: torch.randn(*s, dtype=torch.bfloat16) * 0.1)(H, D, M) * ((H * D) ** -0.5)),
        }
    _A_in = _A_setup()

    def _B_setup():
        B, Sq, D = 1, 1, 512
        H, Sk, Dh = 32, 8192, 128
        return {
            "x": _w((lambda *s: torch.randn(*s, dtype=torch.bfloat16) * 1.6)(B, Sq, D)),
            "k_cache": _w((lambda *s: torch.randn(*s, dtype=torch.bfloat16) * 1.6)(B, H, Sk, Dh)),
            "v_cache": _w((lambda *s: torch.randn(*s, dtype=torch.bfloat16) * 0.05)(B, H, Sk, Dh)),
            "wq": _w((lambda *s: torch.randn(*s, dtype=torch.bfloat16) * 1.6)(D, H * Dh) * (D ** -0.5)),
            "wo": _w((lambda *s: torch.randn(*s, dtype=torch.bfloat16) * 0.05)(H * Dh, D) * ((H * Dh) ** -0.5)),
        }
    _B_in = _B_setup()

    return {
        "A_x": _A_in["x"],
        "A_c_kv": _A_in["c_kv"],
        "A_w_q": _A_in["w_q"],
        "A_w_uk": _A_in["w_uk"],
        "A_w_uv": _A_in["w_uv"],
        "A_w_o": _A_in["w_o"],
        "B_x": _B_in["x"],
        "B_k_cache": _B_in["k_cache"],
        "B_v_cache": _B_in["v_cache"],
        "B_wq": _B_in["wq"],
        "B_wo": _B_in["wo"],
    }

def reference(A_x, A_c_kv, A_w_q, A_w_uk, A_w_uv, A_w_o, B_x, B_k_cache, B_v_cache, B_wq, B_wo):
    def _A_ref(x, c_kv, w_q, w_uk, w_uv, w_o):
        B, Sq, M = x.shape[0], x.shape[1], x.shape[2]
        Sk = c_kv.shape[1]
        H, D = w_q.shape[1], w_q.shape[2]
        q = torch.einsum("bqm,mhd->bhqd", x, w_q)
        k = torch.einsum("bkc,chd->bhkd", c_kv, w_uk)
        v = torch.einsum("bkc,chd->bhkd", c_kv, w_uv)
        scores = torch.einsum("bhqd,bhkd->bhqk", q, k) * (D ** -0.5)
        off = Sk - Sq
        qi = torch.arange(Sq)[:, None]
        kj = torch.arange(Sk)[None, :]
        cmask = kj <= (qi + off)
        scores = torch.where(cmask[None, None], scores, -1e9)
        p = _softmax(scores, axis=-1)
        ctx = torch.einsum("bhqk,bhkd->bhqd", p, v)
        return torch.einsum("bhqd,hdm->bqm", ctx, w_o)

    def _B_ref(x, k_cache, v_cache, wq, wo):
        B, Sq, D = x.shape
        H, Dh = 32, 128
        q = (lambda x, *d: x.permute(*d))((x @ wq).reshape(B, Sq, H, Dh), 0, 2, 1, 3)
        scores = torch.einsum("bhqd,bhkd->bhqk", q, k_cache) * (Dh ** -0.5)
        p = _softmax(scores, axis=-1)
        o = torch.einsum("bhqk,bhkd->bhqd", p, v_cache)
        return (lambda x, *d: x.permute(*d))(o, 0, 2, 1, 3).reshape(B, Sq, H * Dh) @ wo

    a = _A_ref(A_x, A_c_kv, A_w_q, A_w_uk, A_w_uv, A_w_o)
    b = _B_ref(B_x, B_k_cache, B_v_cache, B_wq, B_wo)
    return torch.concatenate([a, b], axis=-1)
```

```asm
; @launch grid=(256,1,1) block=(512,1,1) lds=163840
.amdgcn_target "amdgcn-amd-amdhsa--gfx950"
.text
.globl concat_heads__compressed_kv_cla__mha_block_cached__decode_kernel
.p2align 8
.type concat_heads__compressed_kv_cla__mha_block_cached__decode_kernel,@function
concat_heads__compressed_kv_cla__mha_block_cached__decode_kernel:
    s_cmp_ge_u32 s2, 256
    s_cbranch_scc1 L_end
    s_load_dwordx16 s[4:19], s[0:1], 0
    s_load_dwordx8 s[20:27], s[0:1], 64
    s_load_dwordx2 s[30:31], s[0:1], 104
    v_lshrrev_b32 v1, 6, v0
    v_and_b32 v0, 63, v0
    v_readfirstlane_b32 s3, v1
    s_lshr_b32 s32, s2, 3
    s_add_u32 s33, s2, s32
    s_and_b32 s33, s33, 7
    v_and_b32 v11, 15, v0
    v_lshrrev_b32 v12, 4, v0
    s_mov_b32 s60, 0x3e0293ee
    v_lshlrev_b32 v26, 4, v0
    v_and_b32 v10, 3, v0
    v_lshlrev_b32 v10, 4, v10
    v_lshl_add_u32 v10, v12, 6, v10
    v_bfe_u32 v9, v0, 2, 2
    v_mov_b32 v25, 136192
    s_cmp_lt_u32 s3, 4
    s_cbranch_scc1 L_stream
L_notstream:
    s_cmp_ge_u32 s3, 6
    s_cbranch_scc1 L_w67
    s_setprio 3
    s_and_b32 s56, s33, 3
    s_mul_i32 s56, s56, 5
    s_xor_b32 s32, s32, s56
    s_and_b32 s29, s33, 3
    s_lshl_b32 s29, s29, 1
    s_add_u32 s29, s29, s3
    s_sub_u32 s29, s29, 4
    v_lshlrev_b32 v13, 17, v12
    v_lshl_add_u32 v13, v11, 4, v13
    s_lshl_b32 s57, s29, 19
    s_lshl_b32 s58, s32, 8
    s_add_u32 s57, s57, s58
    s_lshl_b32 s56, s29, 7
    v_lshl_add_u32 v14, v12, 5, s56
    s_mov_b32 s38, 0x400000
    s_mov_b32 s39, 0x20000
    s_movk_i32 s42, 1024
    s_mov_b32 s43, 0x20000
    s_cmp_lt_u32 s33, 4
    s_waitcnt lgkmcnt(0)
    s_cselect_b64 s[36:37], s[8:9], s[22:23]
    s_cselect_b64 s[40:41], s[4:5], s[16:17]
    buffer_load_dwordx4 v[16:19], v14, s[40:43], 0 offen
    buffer_load_dwordx4 v[20:23], v14, s[40:43], 0 offen offset:16
    s_mov_b32 s56, s57
    buffer_load_dwordx4 v[128:131], v13, s[36:39], s56 offen nt
    s_addk_i32 s56, 8192
    buffer_load_dwordx4 v[132:135], v13, s[36:39], s56 offen nt
    s_addk_i32 s56, 8192
    buffer_load_dwordx4 v[136:139], v13, s[36:39], s56 offen nt
    s_addk_i32 s56, 8192
    buffer_load_dwordx4 v[140:143], v13, s[36:39], s56 offen nt
    s_addk_i32 s56, 8192
    buffer_load_dwordx4 v[144:147], v13, s[36:39], s56 offen nt
    s_addk_i32 s56, 8192
    buffer_load_dwordx4 v[148:151], v13, s[36:39], s56 offen nt
    s_addk_i32 s56, 8192
    buffer_load_dwordx4 v[152:155], v13, s[36:39], s56 offen nt
    s_addk_i32 s56, 8192
    buffer_load_dwordx4 v[156:159], v13, s[36:39], s56 offen nt
    s_addk_i32 s56, 8192
    buffer_load_dwordx4 v[160:163], v13, s[36:39], s56 offen nt
    s_addk_i32 s56, 8192
    buffer_load_dwordx4 v[164:167], v13, s[36:39], s56 offen nt
    s_addk_i32 s56, 8192
    buffer_load_dwordx4 v[168:171], v13, s[36:39], s56 offen nt
    s_addk_i32 s56, 8192
    buffer_load_dwordx4 v[172:175], v13, s[36:39], s56 offen nt
    s_addk_i32 s56, 8192
    buffer_load_dwordx4 v[176:179], v13, s[36:39], s56 offen nt
    s_addk_i32 s56, 8192
    buffer_load_dwordx4 v[180:183], v13, s[36:39], s56 offen nt
    s_addk_i32 s56, 8192
    buffer_load_dwordx4 v[184:187], v13, s[36:39], s56 offen nt
    s_addk_i32 s56, 8192
    buffer_load_dwordx4 v[188:191], v13, s[36:39], s56 offen nt
    s_load_dwordx2 s[34:35], s[30:31], 0
    s_cmp_lt_u32 s33, 4
    s_cbranch_scc0 L_wb
    v_lshl_add_u32 v15, v9, 17, v10
    s_mov_b64 s[36:37], s[10:11]
    s_mov_b32 s56, s57
    buffer_load_dwordx4 v[64:67], v15, s[36:39], s56 offen nt
    s_addk_i32 s56, 8192
    buffer_load_dwordx4 v[68:71], v15, s[36:39], s56 offen nt
    s_addk_i32 s56, 8192
    buffer_load_dwordx4 v[72:75], v15, s[36:39], s56 offen nt
    s_addk_i32 s56, 8192
    buffer_load_dwordx4 v[76:79], v15, s[36:39], s56 offen nt
    s_addk_i32 s56, 8192
    buffer_load_dwordx4 v[80:83], v15, s[36:39], s56 offen nt
    s_addk_i32 s56, 8192
    buffer_load_dwordx4 v[84:87], v15, s[36:39], s56 offen nt
    s_addk_i32 s56, 8192
    buffer_load_dwordx4 v[88:91], v15, s[36:39], s56 offen nt
    s_addk_i32 s56, 8192
    buffer_load_dwordx4 v[92:95], v15, s[36:39], s56 offen nt
    s_addk_i32 s56, 8192
    buffer_load_dwordx4 v[96:99], v15, s[36:39], s56 offen nt
    s_addk_i32 s56, 8192
    buffer_load_dwordx4 v[100:103], v15, s[36:39], s56 offen nt
    s_addk_i32 s56, 8192
    buffer_load_dwordx4 v[104:107], v15, s[36:39], s56 offen nt
    s_addk_i32 s56, 8192
    buffer_load_dwordx4 v[108:111], v15, s[36:39], s56 offen nt
    s_addk_i32 s56, 8192
    buffer_load_dwordx4 v[112:115], v15, s[36:39], s56 offen nt
    s_addk_i32 s56, 8192
    buffer_load_dwordx4 v[116:119], v15, s[36:39], s56 offen nt
    s_addk_i32 s56, 8192
    buffer_load_dwordx4 v[120:123], v15, s[36:39], s56 offen nt
    s_addk_i32 s56, 8192
    buffer_load_dwordx4 v[124:127], v15, s[36:39], s56 offen nt
    s_barrier
    s_mov_b32 s44, s30
    s_mov_b32 s45, s31
    s_mov_b32 s46, 0x200000
    s_mov_b32 s47, 0x20000
    v_and_b32 v24, 1, v0
    v_cmp_eq_u32 vcc, 1, v24
    v_mov_b32 v28, 0xc0c0100
    v_mov_b32 v1, 0x1000c0c
    v_cndmask_b32 v28, v28, v1, vcc
    v_mov_b32 v29, 0xc0c0302
    v_mov_b32 v1, 0x3020c0c
    v_cndmask_b32 v29, v29, v1, vcc
    v_bfe_u32 v24, v0, 1, 2
    v_cmp_eq_u32 vcc, 0, v24
    v_mov_b32 v1, 0x0c0c0c0c
    v_mov_b32 v2, 0x0c0c0c0c
    v_cndmask_b32 v1, v1, v28, vcc
    v_cndmask_b32 v2, v2, v29, vcc
    v_cmp_eq_u32 vcc, 1, v24
    v_mov_b32 v3, 0x0c0c0c0c
    v_mov_b32 v4, 0x0c0c0c0c
    v_cndmask_b32 v3, v3, v28, vcc
    v_cndmask_b32 v4, v4, v29, vcc
    v_cmp_eq_u32 vcc, 2, v24
    v_mov_b32 v5, 0x0c0c0c0c
    v_mov_b32 v6, 0x0c0c0c0c
    v_cndmask_b32 v5, v5, v28, vcc
    v_cndmask_b32 v6, v6, v29, vcc
    v_cmp_eq_u32 vcc, 3, v24
    v_mov_b32 v7, 0x0c0c0c0c
    v_mov_b32 v8, 0x0c0c0c0c
    v_cndmask_b32 v7, v7, v28, vcc
    v_cndmask_b32 v8, v8, v29, vcc
    v_lshlrev_b32 v27, 4, v11
    v_bfe_u32 v24, v0, 4, 1
    v_lshl_add_u32 v27, v24, 3, v27
    v_lshrrev_b32 v24, 5, v0
    v_lshl_add_u32 v27, v24, 2, v27
    s_mov_b32 s8, 0x07060501
    s_mov_b32 s9, 0x07060502
    s_mov_b32 s10, 0x07060503
    s_mov_b32 s11, 0x0c04000c
    s_waitcnt vmcnt(32)
    v_perm_b32 v40, v16, v16, v1
    v_perm_b32 v41, v16, v16, v3
    v_perm_b32 v42, v16, v16, v5
    v_perm_b32 v43, v16, v16, v7
    v_perm_b32 v44, v16, v16, v2
    v_perm_b32 v45, v16, v16, v4
    v_perm_b32 v46, v16, v16, v6
    v_perm_b32 v47, v16, v16, v8
    s_waitcnt vmcnt(31)
    v_mfma_f32_16x16x32_bf16 v[28:31], v[40:43], v[128:131], 0
    v_perm_b32 v40, v17, v17, v1
    v_perm_b32 v41, v17, v17, v3
    v_perm_b32 v42, v17, v17, v5
    v_perm_b32 v43, v17, v17, v7
    s_waitcnt vmcnt(30)
    v_mfma_f32_16x16x32_bf16 v[28:31], v[44:47], v[132:135], v[28:31]
    v_perm_b32 v44, v17, v17, v2
    v_perm_b32 v45, v17, v17, v4
    v_perm_b32 v46, v17, v17, v6
    v_perm_b32 v47, v17, v17, v8
    s_waitcnt vmcnt(29)
    v_mfma_f32_16x16x32_bf16 v[28:31], v[40:43], v[136:139], v[28:31]
    v_perm_b32 v40, v18, v18, v1
    v_perm_b32 v41, v18, v18, v3
    v_perm_b32 v42, v18, v18, v5
    v_perm_b32 v43, v18, v18, v7
    s_waitcnt vmcnt(28)
    v_mfma_f32_16x16x32_bf16 v[28:31], v[44:47], v[140:143], v[28:31]
    v_perm_b32 v44, v18, v18, v2
    v_perm_b32 v45, v18, v18, v4
    v_perm_b32 v46, v18, v18, v6
    v_perm_b32 v47, v18, v18, v8
    s_waitcnt vmcnt(27)
    v_mfma_f32_16x16x32_bf16 v[28:31], v[40:43], v[144:147], v[28:31]
    v_perm_b32 v40, v19, v19, v1
    v_perm_b32 v41, v19, v19, v3
    v_perm_b32 v42, v19, v19, v5
    v_perm_b32 v43, v19, v19, v7
    s_waitcnt vmcnt(26)
    v_mfma_f32_16x16x32_bf16 v[28:31], v[44:47], v[148:151], v[28:31]
    v_perm_b32 v44, v19, v19, v2
    v_perm_b32 v45, v19, v19, v4
    v_perm_b32 v46, v19, v19, v6
    v_perm_b32 v47, v19, v19, v8
    s_waitcnt vmcnt(25)
    v_mfma_f32_16x16x32_bf16 v[28:31], v[40:43], v[152:155], v[28:31]
    v_perm_b32 v40, v20, v20, v1
    v_perm_b32 v41, v20, v20, v3
    v_perm_b32 v42, v20, v20, v5
    v_perm_b32 v43, v20, v20, v7
    s_waitcnt vmcnt(24)
    v_mfma_f32_16x16x32_bf16 v[28:31], v[44:47], v[156:159], v[28:31]
    v_perm_b32 v44, v20, v20, v2
    v_perm_b32 v45, v20, v20, v4
    v_perm_b32 v46, v20, v20, v6
    v_perm_b32 v47, v20, v20, v8
    s_waitcnt vmcnt(23)
    v_mfma_f32_16x16x32_bf16 v[28:31], v[40:43], v[160:163], v[28:31]
    v_perm_b32 v40, v21, v21, v1
    v_perm_b32 v41, v21, v21, v3
    v_perm_b32 v42, v21, v21, v5
    v_perm_b32 v43, v21, v21, v7
    s_waitcnt vmcnt(22)
    v_mfma_f32_16x16x32_bf16 v[28:31], v[44:47], v[164:167], v[28:31]
    v_perm_b32 v44, v21, v21, v2
    v_perm_b32 v45, v21, v21, v4
    v_perm_b32 v46, v21, v21, v6
    v_perm_b32 v47, v21, v21, v8
    s_waitcnt vmcnt(21)
    v_mfma_f32_16x16x32_bf16 v[28:31], v[40:43], v[168:171], v[28:31]
    v_perm_b32 v40, v22, v22, v1
    v_perm_b32 v41, v22, v22, v3
    v_perm_b32 v42, v22, v22, v5
    v_perm_b32 v43, v22, v22, v7
    s_waitcnt vmcnt(20)
    v_mfma_f32_16x16x32_bf16 v[28:31], v[44:47], v[172:175], v[28:31]
    v_perm_b32 v44, v22, v22, v2
    v_perm_b32 v45, v22, v22, v4
    v_perm_b32 v46, v22, v22, v6
    v_perm_b32 v47, v22, v22, v8
    s_waitcnt vmcnt(19)
    v_mfma_f32_16x16x32_bf16 v[28:31], v[40:43], v[176:179], v[28:31]
    v_perm_b32 v40, v23, v23, v1
    v_perm_b32 v41, v23, v23, v3
    v_perm_b32 v42, v23, v23, v5
    v_perm_b32 v43, v23, v23, v7
    s_waitcnt vmcnt(18)
    v_mfma_f32_16x16x32_bf16 v[28:31], v[44:47], v[180:183], v[28:31]
    v_perm_b32 v44, v23, v23, v2
    v_perm_b32 v45, v23, v23, v4
    v_perm_b32 v46, v23, v23, v6
    v_perm_b32 v47, v23, v23, v8
    s_waitcnt vmcnt(17)
    v_mfma_f32_16x16x32_bf16 v[28:31], v[40:43], v[184:187], v[28:31]
    s_waitcnt vmcnt(16)
    v_mfma_f32_16x16x32_bf16 v[28:31], v[44:47], v[188:191], v[28:31]
    s_waitcnt lgkmcnt(0)
    s_add_u32 s4, s34, 0x9e3779b9
    s_add_u32 s5, s35, 0x9e3779b9
    s_mov_b32 s34, s5
    v_add_u32 v15, 142336, v26
    s_cmp_eq_u32 s3, 4
    s_cbranch_scc1 L_mrg5
    s_nop 4
    ds_write_b128 v15, v[28:31]
    v_mov_b32 v24, s5
    ds_write_b32 v25, v24 offset:44
    v_mov_b32 v33, 1
    s_mov_b64 exec, 1
    ds_add_u32 v25, v33 offset:24
    s_mov_b64 exec, -1
    s_branch L_wa_q5
L_mrg5:
    s_lshl_b32 s57, s32, 11
    s_add_u32 s57, s57, 196608
    s_lshl_b32 s56, s29, 8
    s_add_u32 s56, s56, s57
    s_mov_b32 s63, 0
L_flag6:
    ds_read_b32 v24, v25 offset:24
    s_add_u32 s63, s63, 1
    s_waitcnt lgkmcnt(0)
    v_cmp_gt_u32 vcc, 1, v24
    s_cbranch_vccz L_flag6_ok
    s_cmp_lt_u32 s63, 2000000
    s_cbranch_scc1 L_flag6
L_flag6_ok:
    ds_read_b128 v[40:43], v15
    v_mov_b32 v35, s34
    s_waitcnt lgkmcnt(0)
    v_add_f32 v40, v40, v28
    v_add_f32 v41, v41, v29
    v_add_f32 v42, v42, v30
    v_add_f32 v43, v43, v31
    v_perm_b32 v32, v40, v43, s8
    v_perm_b32 v33, v41, v43, s9
    v_perm_b32 v34, v42, v43, s10
    s_mov_b32 exec_hi, 0
    buffer_store_dwordx4 v[32:35], v26, s[44:47], s56 offen sc1
    s_mov_b64 exec, -1
    s_and_b32 s56, s32, 0
    s_or_b32 s56, s56, s29
    s_cbranch_scc1 L_noinit2
    s_lshl_b32 s56, s32, 8
    s_add_u32 s56, s56, 8192
    s_mov_b64 exec, 1
    buffer_store_dword v35, v26, s[44:47], s56 offen sc1
    s_mov_b64 exec, -1
L_noinit2:
    s_add_u32 s64, s30, s57
    s_addc_u32 s65, s31, 0
    s_mov_b32 s63, 0
L_pre7:
    s_load_dword s68, s[64:65], 508 glc
    s_load_dword s69, s[64:65], 1020 glc
    s_load_dword s70, s[64:65], 1532 glc
    s_load_dword s71, s[64:65], 2044 glc
    s_mov_b32 s58, 0
    s_add_u32 s63, s63, 1
    s_waitcnt lgkmcnt(0)
    s_cmp_lg_u32 s68, s34
    s_addc_u32 s58, s58, 0
    s_cmp_lg_u32 s69, s34
    s_addc_u32 s58, s58, 0
    s_cmp_lg_u32 s70, s34
    s_addc_u32 s58, s58, 0
    s_cmp_lg_u32 s71, s34
    s_addc_u32 s58, s58, 0
    s_cmp_le_u32 s58, 0
    s_cbranch_scc1 L_pre7_ok
    s_sleep 2
    s_cmp_lt_u32 s63, 200000
    s_cbranch_scc1 L_pre7
L_pre7_ok:
    s_mov_b32 s63, 0
    buffer_load_dwordx4 v[56:59], v26, s[44:47], s57 offen offset:0 sc1
    buffer_load_dwordx4 v[60:63], v26, s[44:47], s57 offen offset:1024 sc1
L_poll8:
    s_waitcnt vmcnt(0)
    v_cmp_ne_u32 s[68:69], s34, v59
    v_cmp_ne_u32 s[70:71], s34, v63
    s_nop 0
    s_or_b64 vcc, s[68:69], s[70:71]
    s_cbranch_scc0 L_poll8_ok
    s_mov_b64 exec, s[68:69]
    buffer_load_dwordx4 v[56:59], v26, s[44:47], s57 offen offset:0 sc1
    s_mov_b64 exec, s[70:71]
    buffer_load_dwordx4 v[60:63], v26, s[44:47], s57 offen offset:1024 sc1
    s_mov_b64 exec, -1
    s_add_u32 s63, s63, 1
    s_cmp_lt_u32 s63, 200000
    s_cbranch_scc1 L_poll8
    s_waitcnt vmcnt(0)
L_poll8_ok:
    v_perm_b32 v59, v57, v56, s11
    v_perm_b32 v63, v61, v60, s11
    v_lshl_or_b32 v59, v58, 24, v59
    v_lshl_or_b32 v63, v62, 24, v63
    v_add_f32 v56, v56, v60
    v_add_f32 v57, v57, v61
    v_add_f32 v58, v58, v62
    v_add_f32 v59, v59, v63
    v_add_u32 v15, 135424, v27
    v_permlane32_swap_b32 v56, v58
    v_permlane32_swap_b32 v57, v59
    v_add_f32 v32, v56, v58
    v_add_f32 v33, v57, v59
    v_cvt_pk_bf16_f32 v24, v32, v33
    ds_write_b32 v15, v24
    v_mov_b32 v24, 1
    s_mov_b64 exec, 1
    ds_add_u32 v25, v24 offset:28
    s_mov_b64 exec, -1
L_wa_q5:
    s_mov_b32 s63, 0
L_flag9:
    ds_read_b32 v24, v25 offset:28
    s_add_u32 s63, s63, 1
    s_waitcnt lgkmcnt(0)
    v_cmp_gt_u32 vcc, 1, v24
    s_cbranch_vccz L_flag9_ok
    s_sleep 1
    s_cmp_lt_u32 s63, 2000000
    s_cbranch_scc1 L_flag9
L_flag9_ok:
    v_add_u32 v15, 135424, v10
    ds_read_b128 v[16:19], v15
    v_and_b32 v14, 1, v0
    v_cmp_ne_u32 s[64:65], 0, v14
    v_and_b32 v14, 2, v0
    v_cmp_ne_u32 s[66:67], 0, v14
    s_lshl_b32 s56, s32, 3
    s_add_u32 s56, s56, s29
    s_lshl_b32 s56, s56, 8
    s_add_u32 s56, s56, 65536
    s_waitcnt vmcnt(0) lgkmcnt(0)
    v_mfma_f32_16x16x32_bf16 v[128:131], v[64:67], v[16:19], 0
    v_mfma_f32_16x16x32_bf16 v[132:135], v[68:71], v[16:19], 0
    v_mfma_f32_16x16x32_bf16 v[136:139], v[72:75], v[16:19], 0
    v_mfma_f32_16x16x32_bf16 v[140:143], v[76:79], v[16:19], 0
    v_mfma_f32_16x16x32_bf16 v[144:147], v[80:83], v[16:19], 0
    v_mfma_f32_16x16x32_bf16 v[148:151], v[84:87], v[16:19], 0
    v_mfma_f32_16x16x32_bf16 v[152:155], v[88:91], v[16:19], 0
    v_mfma_f32_16x16x32_bf16 v[156:159], v[92:95], v[16:19], 0
    v_mfma_f32_16x16x32_bf16 v[160:163], v[96:99], v[16:19], 0
    v_mfma_f32_16x16x32_bf16 v[164:167], v[100:103], v[16:19], 0
    v_mfma_f32_16x16x32_bf16 v[168:171], v[104:107], v[16:19], 0
    v_mfma_f32_16x16x32_bf16 v[172:175], v[108:111], v[16:19], 0
    v_mfma_f32_16x16x32_bf16 v[176:179], v[112:115], v[16:19], 0
    v_mfma_f32_16x16x32_bf16 v[180:183], v[116:119], v[16:19], 0
    v_mfma_f32_16x16x32_bf16 v[184:187], v[120:123], v[16:19], 0
    v_mfma_f32_16x16x32_bf16 v[188:191], v[124:127], v[16:19], 0
    v_mov_b32_dpp v30, v128 quad_perm:[0,0,0,0] row_mask:0xf bank_mask:0xf
    v_mov_b32_dpp v31, v132 quad_perm:[0,0,0,0] row_mask:0xf bank_mask:0xf
    v_mov_b32_dpp v32, v136 quad_perm:[0,0,0,0] row_mask:0xf bank_mask:0xf
    v_mov_b32_dpp v33, v140 quad_perm:[0,0,0,0] row_mask:0xf bank_mask:0xf
    v_mov_b32_dpp v34, v144 quad_perm:[0,0,0,0] row_mask:0xf bank_mask:0xf
    v_mov_b32_dpp v35, v148 quad_perm:[0,0,0,0] row_mask:0xf bank_mask:0xf
    v_mov_b32_dpp v36, v152 quad_perm:[0,0,0,0] row_mask:0xf bank_mask:0xf
    v_mov_b32_dpp v37, v156 quad_perm:[0,0,0,0] row_mask:0xf bank_mask:0xf
    v_mov_b32_dpp v38, v160 quad_perm:[0,0,0,0] row_mask:0xf bank_mask:0xf
    v_mov_b32_dpp v39, v164 quad_perm:[0,0,0,0] row_mask:0xf bank_mask:0xf
    v_mov_b32_dpp v40, v168 quad_perm:[0,0,0,0] row_mask:0xf bank_mask:0xf
    v_mov_b32_dpp v41, v172 quad_perm:[0,0,0,0] row_mask:0xf bank_mask:0xf
    v_mov_b32_dpp v42, v176 quad_perm:[0,0,0,0] row_mask:0xf bank_mask:0xf
    v_mov_b32_dpp v43, v180 quad_perm:[0,0,0,0] row_mask:0xf bank_mask:0xf
    v_mov_b32_dpp v44, v184 quad_perm:[0,0,0,0] row_mask:0xf bank_mask:0xf
    v_mov_b32_dpp v45, v188 quad_perm:[0,0,0,0] row_mask:0xf bank_mask:0xf
    v_add_f32_dpp v30, v129, v30 quad_perm:[1,1,1,1] row_mask:0xf bank_mask:0xf
    v_add_f32_dpp v31, v133, v31 quad_perm:[1,1,1,1] row_mask:0xf bank_mask:0xf
    v_add_f32_dpp v32, v137, v32 quad_perm:[1,1,1,1] row_mask:0xf bank_mask:0xf
    v_add_f32_dpp v33, v141, v33 quad_perm:[1,1,1,1] row_mask:0xf bank_mask:0xf
    v_add_f32_dpp v34, v145, v34 quad_perm:[1,1,1,1] row_mask:0xf bank_mask:0xf
    v_add_f32_dpp v35, v149, v35 quad_perm:[1,1,1,1] row_mask:0xf bank_mask:0xf
    v_add_f32_dpp v36, v153, v36 quad_perm:[1,1,1,1] row_mask:0xf bank_mask:0xf
    v_add_f32_dpp v37, v157, v37 quad_perm:[1,1,1,1] row_mask:0xf bank_mask:0xf
    v_add_f32_dpp v38, v161, v38 quad_perm:[1,1,1,1] row_mask:0xf bank_mask:0xf
    v_add_f32_dpp v39, v165, v39 quad_perm:[1,1,1,1] row_mask:0xf bank_mask:0xf
    v_add_f32_dpp v40, v169, v40 quad_perm:[1,1,1,1] row_mask:0xf bank_mask:0xf
    v_add_f32_dpp v41, v173, v41 quad_perm:[1,1,1,1] row_mask:0xf bank_mask:0xf
    v_add_f32_dpp v42, v177, v42 quad_perm:[1,1,1,1] row_mask:0xf bank_mask:0xf
    v_add_f32_dpp v43, v181, v43 quad_perm:[1,1,1,1] row_mask:0xf bank_mask:0xf
    v_add_f32_dpp v44, v185, v44 quad_perm:[1,1,1,1] row_mask:0xf bank_mask:0xf
    v_add_f32_dpp v45, v189, v45 quad_perm:[1,1,1,1] row_mask:0xf bank_mask:0xf
    v_add_f32_dpp v30, v130, v30 quad_perm:[2,2,2,2] row_mask:0xf bank_mask:0xf
    v_add_f32_dpp v31, v134, v31 quad_perm:[2,2,2,2] row_mask:0xf bank_mask:0xf
    v_add_f32_dpp v32, v138, v32 quad_perm:[2,2,2,2] row_mask:0xf bank_mask:0xf
    v_add_f32_dpp v33, v142, v33 quad_perm:[2,2,2,2] row_mask:0xf bank_mask:0xf
    v_add_f32_dpp v34, v146, v34 quad_perm:[2,2,2,2] row_mask:0xf bank_mask:0xf
    v_add_f32_dpp v35, v150, v35 quad_perm:[2,2,2,2] row_mask:0xf bank_mask:0xf
    v_add_f32_dpp v36, v154, v36 quad_perm:[2,2,2,2] row_mask:0xf bank_mask:0xf
    v_add_f32_dpp v37, v158, v37 quad_perm:[2,2,2,2] row_mask:0xf bank_mask:0xf
    v_add_f32_dpp v38, v162, v38 quad_perm:[2,2,2,2] row_mask:0xf bank_mask:0xf
    v_add_f32_dpp v39, v166, v39 quad_perm:[2,2,2,2] row_mask:0xf bank_mask:0xf
    v_add_f32_dpp v40, v170, v40 quad_perm:[2,2,2,2] row_mask:0xf bank_mask:0xf
    v_add_f32_dpp v41, v174, v41 quad_perm:[2,2,2,2] row_mask:0xf bank_mask:0xf
    v_add_f32_dpp v42, v178, v42 quad_perm:[2,2,2,2] row_mask:0xf bank_mask:0xf
    v_add_f32_dpp v43, v182, v43 quad_perm:[2,2,2,2] row_mask:0xf bank_mask:0xf
    v_add_f32_dpp v44, v186, v44 quad_perm:[2,2,2,2] row_mask:0xf bank_mask:0xf
    v_add_f32_dpp v45, v190, v45 quad_perm:[2,2,2,2] row_mask:0xf bank_mask:0xf
    v_add_f32_dpp v30, v131, v30 quad_perm:[3,3,3,3] row_mask:0xf bank_mask:0xf
    v_add_f32_dpp v31, v135, v31 quad_perm:[3,3,3,3] row_mask:0xf bank_mask:0xf
    v_add_f32_dpp v32, v139, v32 quad_perm:[3,3,3,3] row_mask:0xf bank_mask:0xf
    v_add_f32_dpp v33, v143, v33 quad_perm:[3,3,3,3] row_mask:0xf bank_mask:0xf
    v_add_f32_dpp v34, v147, v34 quad_perm:[3,3,3,3] row_mask:0xf bank_mask:0xf
    v_add_f32_dpp v35, v151, v35 quad_perm:[3,3,3,3] row_mask:0xf bank_mask:0xf
    v_add_f32_dpp v36, v155, v36 quad_perm:[3,3,3,3] row_mask:0xf bank_mask:0xf
    v_add_f32_dpp v37, v159, v37 quad_perm:[3,3,3,3] row_mask:0xf bank_mask:0xf
    v_add_f32_dpp v38, v163, v38 quad_perm:[3,3,3,3] row_mask:0xf bank_mask:0xf
    v_add_f32_dpp v39, v167, v39 quad_perm:[3,3,3,3] row_mask:0xf bank_mask:0xf
    v_add_f32_dpp v40, v171, v40 quad_perm:[3,3,3,3] row_mask:0xf bank_mask:0xf
    v_add_f32_dpp v41, v175, v41 quad_perm:[3,3,3,3] row_mask:0xf bank_mask:0xf
    v_add_f32_dpp v42, v179, v42 quad_perm:[3,3,3,3] row_mask:0xf bank_mask:0xf
    v_add_f32_dpp v43, v183, v43 quad_perm:[3,3,3,3] row_mask:0xf bank_mask:0xf
    v_add_f32_dpp v44, v187, v44 quad_perm:[3,3,3,3] row_mask:0xf bank_mask:0xf
    v_add_f32_dpp v45, v191, v45 quad_perm:[3,3,3,3] row_mask:0xf bank_mask:0xf
    v_cvt_pk_bf16_f32 v46, v30, v31
    v_cvt_pk_bf16_f32 v47, v32, v33
    v_cvt_pk_bf16_f32 v48, v34, v35
    v_cvt_pk_bf16_f32 v49, v36, v37
    v_cvt_pk_bf16_f32 v50, v38, v39
    v_cvt_pk_bf16_f32 v51, v40, v41
    v_cvt_pk_bf16_f32 v52, v42, v43
    v_cvt_pk_bf16_f32 v53, v44, v45
    v_cndmask_b32 v46, v46, v50, s[66:67]
    v_cndmask_b32 v47, v47, v51, s[66:67]
    v_cndmask_b32 v48, v48, v52, s[66:67]
    v_cndmask_b32 v49, v49, v53, s[66:67]
    v_cndmask_b32 v46, v46, v48, s[64:65]
    v_cndmask_b32 v47, v47, v49, s[64:65]
    v_mov_b32 v48, s34
    v_mov_b32 v49, s34
    s_mov_b32 exec_lo, 0x000f000f
    s_mov_b32 exec_hi, 0x000f000f
    buffer_store_dwordx4 v[46:49], v10, s[44:47], s56 offen sc1
    s_mov_b64 exec, -1
    v_lshrrev_b32 v14, 3, v0
    v_lshlrev_b32 v15, 16, v14
    v_and_b32 v16, 7, v0
    v_lshl_add_u32 v15, v16, 4, v15
    s_lshl_b32 s57, s32, 10
    s_lshl_b32 s56, s29, 7
    s_add_u32 s57, s57, s56
    s_add_u32 s57, s57, 1048576
    v_lshlrev_b32 v16, 4, v14
    s_lshl_b32 s58, s32, 8
    s_add_u32 s56, s58, 8192
    s_add_u32 s58, s58, 16384
    s_add_u32 s80, s30, s56
    s_addc_u32 s81, s31, 0
    s_add_u32 s59, s34, 16
    s_cmp_eq_u32 s3, 5
    s_cbranch_scc1 L_pcnt5
    s_mov_b32 s63, 0
L_flag10:
    ds_read_b32 v24, v25 offset:56
    s_add_u32 s63, s63, 1
    s_waitcnt lgkmcnt(0)
    v_cmp_gt_u32 vcc, 4, v24
    s_cbranch_vccz L_flag10_ok
    s_sleep 8
    s_cmp_lt_u32 s63, 2000000
    s_cbranch_scc1 L_flag10
L_flag10_ok:
    s_mov_b32 s63, 0
L_pcnt:
    s_load_dword s56, s[80:81], 0 glc
    s_waitcnt lgkmcnt(0)
    s_cmp_eq_u32 s56, s59
    s_cbranch_scc1 L_pcnt_ok
    s_sleep 24
    s_add_u32 s63, s63, 1
    s_cmp_lt_u32 s63, 200000
    s_cbranch_scc1 L_pcnt
L_pcnt_ok:
    v_mov_b32 v24, 1
    s_mov_b64 exec, 1
    ds_add_u32 v25, v24 offset:28
    s_mov_b64 exec, -1
L_pcnt5:
    s_mov_b32 s63, 0
L_flag11:
    ds_read_b32 v24, v25 offset:28
    s_add_u32 s63, s63, 1
    s_waitcnt lgkmcnt(0)
    v_cmp_gt_u32 vcc, 2, v24
    s_cbranch_vccz L_flag11_ok
    s_sleep 2
    s_cmp_lt_u32 s63, 2000000
    s_cbranch_scc1 L_flag11
L_flag11_ok:
    s_lshl_b32 s56, s3, 14
    s_add_u32 s56, s56, 2048
    v_add_u32 v13, s56, v26
    ds_read_b128 v[192:195], v13 offset:0
    ds_read_b128 v[196:199], v13 offset:1024
    ds_read_b128 v[200:203], v13 offset:2048
    ds_read_b128 v[204:207], v13 offset:3072
    ds_read_b128 v[208:211], v13 offset:4096
    ds_read_b128 v[212:215], v13 offset:5120
    ds_read_b128 v[216:219], v13 offset:6144
    ds_read_b128 v[220:223], v13 offset:7168
    ds_read_b128 v[224:227], v13 offset:8192
    ds_read_b128 v[228:231], v13 offset:9216
    ds_read_b128 v[232:235], v13 offset:10240
    ds_read_b128 v[236:239], v13 offset:11264
    ds_read_b128 v[240:243], v13 offset:12288
    ds_read_b128 v[244:247], v13 offset:13312
    ds_read_b128 v[248:251], v13 offset:14336
    ds_read_b128 v[252:255], v13 offset:15360
    buffer_load_dwordx4 v[48:51], v16, s[44:47], s58 offen sc1
    buffer_load_dwordx4 v[128:131], v15, s[44:47], s57 offen sc1
    s_add_u32 s57, s57, 32768
    buffer_load_dwordx4 v[132:135], v15, s[44:47], s57 offen sc1
    s_add_u32 s57, s57, 32768
    s_lshl_b32 s56, s3, 7
    s_add_u32 s56, s56, 138752
    v_add_u32 v17, s56, v27
    v_lshl_add_u32 v18, v12, 5, s56
    s_waitcnt vmcnt(2)
    v_max_f32 v20, v48, v50
    s_nop 1
    v_max_f32_dpp v20, v20, v20 row_ror:8 row_mask:0xf bank_mask:0xf
    v_mov_b32 v21, v20
    s_nop 1
    v_permlane32_swap_b32 v20, v21
    v_max_f32 v20, v20, v21
    v_mov_b32 v21, v20
    s_nop 1
    v_permlane16_swap_b32 v20, v21
    v_max_f32 v20, v20, v21
    v_mul_f32 v20, s60, v20
    v_fma_f32 v48, v48, s60, -v20
    v_fma_f32 v50, v50, s60, -v20
    v_exp_f32 v48, v48
    v_exp_f32 v50, v50
    s_nop 0
    v_cvt_pk_bf16_f32 v22, v48, v50
    v_lshlrev_b32 v30, 16, v22
    v_and_b32 v31, 0xffff0000, v22
    v_mul_f32 v20, v30, v49
    v_fmac_f32 v20, v31, v51
    s_nop 1
    v_add_f32_dpp v20, v20, v20 row_ror:8 row_mask:0xf bank_mask:0xf
    v_mov_b32 v21, v20
    s_nop 1
    v_permlane32_swap_b32 v20, v21
    v_add_f32 v20, v20, v21
    v_mov_b32 v21, v20
    s_nop 1
    v_permlane16_swap_b32 v20, v21
    v_add_f32 v20, v20, v21
    v_rcp_f32 v20, v20
    v_perm_b32 v40, v22, v22, v1
    v_perm_b32 v41, v22, v22, v3
    v_perm_b32 v42, v22, v22, v5
    v_perm_b32 v43, v22, v22, v7
    v_perm_b32 v44, v22, v22, v2
    v_perm_b32 v45, v22, v22, v4
    v_perm_b32 v46, v22, v22, v6
    v_perm_b32 v47, v22, v22, v8
    s_waitcnt vmcnt(1)
    v_mfma_f32_16x16x32_bf16 v[48:51], v[40:43], v[128:131], 0
    s_waitcnt vmcnt(0)
    v_mfma_f32_16x16x32_bf16 v[48:51], v[44:47], v[132:135], v[48:51]
    s_nop 7
    v_mov_b32_dpp v48, v48 row_ror:8 row_mask:0xc bank_mask:0xf
    v_mov_b32_dpp v49, v49 row_ror:8 row_mask:0xc bank_mask:0xf
    v_mov_b32_dpp v50, v50 row_ror:8 row_mask:0xc bank_mask:0xf
    v_mov_b32_dpp v51, v51 row_ror:8 row_mask:0xc bank_mask:0xf
    s_nop 0
    v_permlane32_swap_b32 v48, v50
    v_permlane32_swap_b32 v49, v51
    v_add_f32 v32, v48, v50
    v_add_f32 v33, v49, v51
    v_mul_f32 v32, v32, v20
    v_mul_f32 v33, v33, v20
    v_cvt_pk_bf16_f32 v24, v32, v33
    s_mov_b32 exec_lo, 0x00ff00ff
    s_mov_b32 exec_hi, 0x00ff00ff
    ds_write_b32 v17, v24
    s_mov_b64 exec, -1
    ds_read_b128 v[32:35], v18
    ds_read_b128 v[36:39], v18 offset:16
    s_waitcnt lgkmcnt(0)
    v_perm_b32 v40, v32, v32, v1
    v_perm_b32 v41, v32, v32, v3
    v_perm_b32 v42, v32, v32, v5
    v_perm_b32 v43, v32, v32, v7
    v_perm_b32 v44, v32, v32, v2
    v_perm_b32 v45, v32, v32, v4
    v_perm_b32 v46, v32, v32, v6
    v_perm_b32 v47, v32, v32, v8
    v_mfma_f32_16x16x32_bf16 v[48:51], v[40:43], v[192:195], 0
    v_perm_b32 v40, v33, v33, v1
    v_perm_b32 v41, v33, v33, v3
    v_perm_b32 v42, v33, v33, v5
    v_perm_b32 v43, v33, v33, v7
    v_mfma_f32_16x16x32_bf16 v[48:51], v[44:47], v[196:199], v[48:51]
    v_perm_b32 v44, v33, v33, v2
    v_perm_b32 v45, v33, v33, v4
    v_perm_b32 v46, v33, v33, v6
    v_perm_b32 v47, v33, v33, v8
    v_mfma_f32_16x16x32_bf16 v[48:51], v[40:43], v[200:203], v[48:51]
    v_perm_b32 v40, v34, v34, v1
    v_perm_b32 v41, v34, v34, v3
    v_perm_b32 v42, v34, v34, v5
    v_perm_b32 v43, v34, v34, v7
    v_mfma_f32_16x16x32_bf16 v[48:51], v[44:47], v[204:207], v[48:51]
    v_perm_b32 v44, v34, v34, v2
    v_perm_b32 v45, v34, v34, v4
    v_perm_b32 v46, v34, v34, v6
    v_perm_b32 v47, v34, v34, v8
    v_mfma_f32_16x16x32_bf16 v[48:51], v[40:43], v[208:211], v[48:51]
    v_perm_b32 v40, v35, v35, v1
    v_perm_b32 v41, v35, v35, v3
    v_perm_b32 v42, v35, v35, v5
    v_perm_b32 v43, v35, v35, v7
    v_mfma_f32_16x16x32_bf16 v[48:51], v[44:47], v[212:215], v[48:51]
    v_perm_b32 v44, v35, v35, v2
    v_perm_b32 v45, v35, v35, v4
    v_perm_b32 v46, v35, v35, v6
    v_perm_b32 v47, v35, v35, v8
    v_mfma_f32_16x16x32_bf16 v[48:51], v[40:43], v[216:219], v[48:51]
    v_perm_b32 v40, v36, v36, v1
    v_perm_b32 v41, v36, v36, v3
    v_perm_b32 v42, v36, v36, v5
    v_perm_b32 v43, v36, v36, v7
    v_mfma_f32_16x16x32_bf16 v[48:51], v[44:47], v[220:223], v[48:51]
    v_perm_b32 v44, v36, v36, v2
    v_perm_b32 v45, v36, v36, v4
    v_perm_b32 v46, v36, v36, v6
    v_perm_b32 v47, v36, v36, v8
    v_mfma_f32_16x16x32_bf16 v[48:51], v[40:43], v[224:227], v[48:51]
    v_perm_b32 v40, v37, v37, v1
    v_perm_b32 v41, v37, v37, v3
    v_perm_b32 v42, v37, v37, v5
    v_perm_b32 v43, v37, v37, v7
    v_mfma_f32_16x16x32_bf16 v[48:51], v[44:47], v[228:231], v[48:51]
    v_perm_b32 v44, v37, v37, v2
    v_perm_b32 v45, v37, v37, v4
    v_perm_b32 v46, v37, v37, v6
    v_perm_b32 v47, v37, v37, v8
    v_mfma_f32_16x16x32_bf16 v[48:51], v[40:43], v[232:235], v[48:51]
    v_perm_b32 v40, v38, v38, v1
    v_perm_b32 v41, v38, v38, v3
    v_perm_b32 v42, v38, v38, v5
    v_perm_b32 v43, v38, v38, v7
    v_mfma_f32_16x16x32_bf16 v[48:51], v[44:47], v[236:239], v[48:51]
    v_perm_b32 v44, v38, v38, v2
    v_perm_b32 v45, v38, v38, v4
    v_perm_b32 v46, v38, v38, v6
    v_perm_b32 v47, v38, v38, v8
    v_mfma_f32_16x16x32_bf16 v[48:51], v[40:43], v[240:243], v[48:51]
    v_perm_b32 v40, v39, v39, v1
    v_perm_b32 v41, v39, v39, v3
    v_perm_b32 v42, v39, v39, v5
    v_perm_b32 v43, v39, v39, v7
    v_mfma_f32_16x16x32_bf16 v[48:51], v[44:47], v[244:247], v[48:51]
    v_perm_b32 v44, v39, v39, v2
    v_perm_b32 v45, v39, v39, v4
    v_perm_b32 v46, v39, v39, v6
    v_perm_b32 v47, v39, v39, v8
    v_mfma_f32_16x16x32_bf16 v[48:51], v[40:43], v[248:251], v[48:51]
    s_nop 0
    v_mfma_f32_16x16x32_bf16 v[48:51], v[44:47], v[252:255], v[48:51]
    v_add_u32 v15, 142336, v26
    s_cmp_eq_u32 s3, 4
    s_cbranch_scc1 L_mrg12
    s_nop 4
    ds_write_b128 v15, v[48:51]
    v_mov_b32 v33, 1
    s_mov_b64 exec, 1
    ds_add_u32 v25, v33 offset:24
    s_mov_b64 exec, -1
    s_branch L_wtail
L_mrg12:
    s_lshl_b32 s57, s32, 11
    s_add_u32 s57, s57, 262144
    s_lshl_b32 s56, s29, 8
    s_add_u32 s56, s56, s57
    s_mov_b32 s63, 0
L_flag13:
    ds_read_b32 v24, v25 offset:24
    s_add_u32 s63, s63, 1
    s_waitcnt lgkmcnt(0)
    v_cmp_gt_u32 vcc, 2, v24
    s_cbranch_vccz L_flag13_ok
    s_cmp_lt_u32 s63, 2000000
    s_cbranch_scc1 L_flag13
L_flag13_ok:
    ds_read_b128 v[40:43], v15
    v_mov_b32 v35, s34
    s_waitcnt lgkmcnt(0)
    v_add_f32 v40, v40, v48
    v_add_f32 v41, v41, v49
    v_add_f32 v42, v42, v50
    v_add_f32 v43, v43, v51
    v_perm_b32 v32, v40, v43, s8
    v_perm_b32 v33, v41, v43, s9
    v_perm_b32 v34, v42, v43, s10
    s_mov_b32 exec_hi, 0
    buffer_store_dwordx4 v[32:35], v26, s[44:47], s56 offen sc1
    s_mov_b64 exec, -1
    s_branch L_wtail
L_wb:
    s_barrier
    s_mov_b32 s44, s30
    s_mov_b32 s45, s31
    s_mov_b32 s46, 0x200000
    s_mov_b32 s47, 0x20000
    s_cmp_eq_u32 s29, 0
    s_cbranch_scc0 L_noinit
    s_lshl_b32 s56, s32, 10
    s_add_u32 s56, s56, 32768
    v_mov_b32 v29, 105
    s_mov_b64 exec, 1
    buffer_store_dword v29, v26, s[44:47], s56 offen sc1
    s_mov_b64 exec, -1
L_noinit:
    v_and_b32 v24, 1, v0
    v_cmp_eq_u32 vcc, 1, v24
    v_mov_b32 v28, 0xc0c0100
    v_mov_b32 v1, 0x1000c0c
    v_cndmask_b32 v28, v28, v1, vcc
    v_mov_b32 v29, 0xc0c0302
    v_mov_b32 v1, 0x3020c0c
    v_cndmask_b32 v29, v29, v1, vcc
    v_bfe_u32 v24, v0, 1, 2
    v_cmp_eq_u32 vcc, 0, v24
    v_mov_b32 v1, 0x0c0c0c0c
    v_mov_b32 v2, 0x0c0c0c0c
    v_cndmask_b32 v1, v1, v28, vcc
    v_cndmask_b32 v2, v2, v29, vcc
    v_cmp_eq_u32 vcc, 1, v24
    v_mov_b32 v3, 0x0c0c0c0c
    v_mov_b32 v4, 0x0c0c0c0c
    v_cndmask_b32 v3, v3, v28, vcc
    v_cndmask_b32 v4, v4, v29, vcc
    v_cmp_eq_u32 vcc, 2, v24
    v_mov_b32 v5, 0x0c0c0c0c
    v_mov_b32 v6, 0x0c0c0c0c
    v_cndmask_b32 v5, v5, v28, vcc
    v_cndmask_b32 v6, v6, v29, vcc
    v_cmp_eq_u32 vcc, 3, v24
    v_mov_b32 v7, 0x0c0c0c0c
    v_mov_b32 v8, 0x0c0c0c0c
    v_cndmask_b32 v7, v7, v28, vcc
    v_cndmask_b32 v8, v8, v29, vcc
    v_lshlrev_b32 v27, 4, v11
    v_bfe_u32 v24, v0, 4, 1
    v_lshl_add_u32 v27, v24, 3, v27
    v_lshrrev_b32 v24, 5, v0
    v_lshl_add_u32 v27, v24, 2, v27
    s_mov_b32 s8, 0x07060501
    s_mov_b32 s9, 0x07060502
    s_mov_b32 s10, 0x07060503
    s_mov_b32 s11, 0x0c04000c
    s_waitcnt vmcnt(16)
    v_perm_b32 v40, v16, v16, v1
    v_perm_b32 v41, v16, v16, v3
    v_perm_b32 v42, v16, v16, v5
    v_perm_b32 v43, v16, v16, v7
    v_perm_b32 v44, v16, v16, v2
    v_perm_b32 v45, v16, v16, v4
    v_perm_b32 v46, v16, v16, v6
    v_perm_b32 v47, v16, v16, v8
    s_waitcnt vmcnt(15)
    v_mfma_f32_16x16x32_bf16 v[28:31], v[40:43], v[128:131], 0
    v_perm_b32 v40, v17, v17, v1
    v_perm_b32 v41, v17, v17, v3
    v_perm_b32 v42, v17, v17, v5
    v_perm_b32 v43, v17, v17, v7
    s_waitcnt vmcnt(14)
    v_mfma_f32_16x16x32_bf16 v[28:31], v[44:47], v[132:135], v[28:31]
    v_perm_b32 v44, v17, v17, v2
    v_perm_b32 v45, v17, v17, v4
    v_perm_b32 v46, v17, v17, v6
    v_perm_b32 v47, v17, v17, v8
    s_waitcnt vmcnt(13)
    v_mfma_f32_16x16x32_bf16 v[28:31], v[40:43], v[136:139], v[28:31]
    v_perm_b32 v40, v18, v18, v1
    v_perm_b32 v41, v18, v18, v3
    v_perm_b32 v42, v18, v18, v5
    v_perm_b32 v43, v18, v18, v7
    s_waitcnt vmcnt(12)
    v_mfma_f32_16x16x32_bf16 v[28:31], v[44:47], v[140:143], v[28:31]
    v_perm_b32 v44, v18, v18, v2
    v_perm_b32 v45, v18, v18, v4
    v_perm_b32 v46, v18, v18, v6
    v_perm_b32 v47, v18, v18, v8
    s_waitcnt vmcnt(11)
    v_mfma_f32_16x16x32_bf16 v[28:31], v[40:43], v[144:147], v[28:31]
    v_perm_b32 v40, v19, v19, v1
    v_perm_b32 v41, v19, v19, v3
    v_perm_b32 v42, v19, v19, v5
    v_perm_b32 v43, v19, v19, v7
    s_waitcnt vmcnt(10)
    v_mfma_f32_16x16x32_bf16 v[28:31], v[44:47], v[148:151], v[28:31]
    v_perm_b32 v44, v19, v19, v2
    v_perm_b32 v45, v19, v19, v4
    v_perm_b32 v46, v19, v19, v6
    v_perm_b32 v47, v19, v19, v8
    s_waitcnt vmcnt(9)
    v_mfma_f32_16x16x32_bf16 v[28:31], v[40:43], v[152:155], v[28:31]
    v_perm_b32 v40, v20, v20, v1
    v_perm_b32 v41, v20, v20, v3
    v_perm_b32 v42, v20, v20, v5
    v_perm_b32 v43, v20, v20, v7
    s_waitcnt vmcnt(8)
    v_mfma_f32_16x16x32_bf16 v[28:31], v[44:47], v[156:159], v[28:31]
    v_perm_b32 v44, v20, v20, v2
    v_perm_b32 v45, v20, v20, v4
    v_perm_b32 v46, v20, v20, v6
    v_perm_b32 v47, v20, v20, v8
    s_waitcnt vmcnt(7)
    v_mfma_f32_16x16x32_bf16 v[28:31], v[40:43], v[160:163], v[28:31]
    v_perm_b32 v40, v21, v21, v1
    v_perm_b32 v41, v21, v21, v3
    v_perm_b32 v42, v21, v21, v5
    v_perm_b32 v43, v21, v21, v7
    s_waitcnt vmcnt(6)
    v_mfma_f32_16x16x32_bf16 v[28:31], v[44:47], v[164:167], v[28:31]
    v_perm_b32 v44, v21, v21, v2
    v_perm_b32 v45, v21, v21, v4
    v_perm_b32 v46, v21, v21, v6
    v_perm_b32 v47, v21, v21, v8
    s_waitcnt vmcnt(5)
    v_mfma_f32_16x16x32_bf16 v[28:31], v[40:43], v[168:171], v[28:31]
    v_perm_b32 v40, v22, v22, v1
    v_perm_b32 v41, v22, v22, v3
    v_perm_b32 v42, v22, v22, v5
    v_perm_b32 v43, v22, v22, v7
    s_waitcnt vmcnt(4)
    v_mfma_f32_16x16x32_bf16 v[28:31], v[44:47], v[172:175], v[28:31]
    v_perm_b32 v44, v22, v22, v2
    v_perm_b32 v45, v22, v22, v4
    v_perm_b32 v46, v22, v22, v6
    v_perm_b32 v47, v22, v22, v8
    s_waitcnt vmcnt(3)
    v_mfma_f32_16x16x32_bf16 v[28:31], v[40:43], v[176:179], v[28:31]
    v_perm_b32 v40, v23, v23, v1
    v_perm_b32 v41, v23, v23, v3
    v_perm_b32 v42, v23, v23, v5
    v_perm_b32 v43, v23, v23, v7
    s_waitcnt vmcnt(2)
    v_mfma_f32_16x16x32_bf16 v[28:31], v[44:47], v[180:183], v[28:31]
    v_perm_b32 v44, v23, v23, v2
    v_perm_b32 v45, v23, v23, v4
    v_perm_b32 v46, v23, v23, v6
    v_perm_b32 v47, v23, v23, v8
    s_waitcnt vmcnt(1)
    v_mfma_f32_16x16x32_bf16 v[28:31], v[40:43], v[184:187], v[28:31]
    s_waitcnt vmcnt(0)
    v_mfma_f32_16x16x32_bf16 v[28:31], v[44:47], v[188:191], v[28:31]
    s_waitcnt lgkmcnt(0)
    s_add_u32 s4, s34, 0x9e3779b9
    s_add_u32 s5, s35, 0x9e3779b9
    s_mov_b32 s34, s4
    v_add_u32 v15, 142336, v26
    s_cmp_eq_u32 s3, 4
    s_cbranch_scc1 L_mrg14
    s_nop 4
    ds_write_b128 v15, v[28:31]
    v_mov_b32 v24, s5
    ds_write_b32 v25, v24 offset:44
    v_mov_b32 v33, 1
    s_mov_b64 exec, 1
    ds_add_u32 v25, v33 offset:24
    s_mov_b64 exec, -1
    s_branch L_wb_q5
L_mrg14:
    s_lshl_b32 s57, s32, 11
    s_add_u32 s57, s57, 131072
    s_lshl_b32 s56, s29, 8
    s_add_u32 s56, s56, s57
    s_mov_b32 s63, 0
L_flag15:
    ds_read_b32 v24, v25 offset:24
    s_add_u32 s63, s63, 1
    s_waitcnt lgkmcnt(0)
    v_cmp_gt_u32 vcc, 1, v24
    s_cbranch_vccz L_flag15_ok
    s_cmp_lt_u32 s63, 2000000
    s_cbranch_scc1 L_flag15
L_flag15_ok:
    ds_read_b128 v[40:43], v15
    v_mov_b32 v35, s34
    s_waitcnt lgkmcnt(0)
    v_add_f32 v40, v40, v28
    v_add_f32 v41, v41, v29
    v_add_f32 v42, v42, v30
    v_add_f32 v43, v43, v31
    v_perm_b32 v32, v40, v43, s8
    v_perm_b32 v33, v41, v43, s9
    v_perm_b32 v34, v42, v43, s10
    s_mov_b32 exec_hi, 0
    buffer_store_dwordx4 v[32:35], v26, s[44:47], s56 offen sc1
    s_mov_b64 exec, -1
L_wb_q5:
    s_cmp_eq_u32 s33, 7
    s_cbranch_scc1 L_acu_w45
L_wtail:
    s_and_b32 s56, s33, 3
    s_mul_i32 s56, s56, 5
    s_xor_b32 s32, s32, s56
L_wtail2:
    s_mov_b32 s36, s24
    s_mov_b32 s37, s25
    s_mov_b32 s38, 0x400000
    s_mov_b32 s39, 0x20000
    s_mov_b32 s52, s14
    s_mov_b32 s53, s15
    s_mov_b32 s54, 0x400000
    s_mov_b32 s55, 0x20000
    v_lshlrev_b32 v15, 1, v12
    v_xor_b32 v15, v15, v11
    v_lshlrev_b32 v15, 4, v15
    v_lshl_add_u32 v30, v12, 10, v15
    v_xor_b32 v31, 128, v30
    s_and_b32 s56, s3, 1
    s_lshl_b32 m0, s56, 14
    v_lshrrev_b32 v14, 3, v0
    v_lshlrev_b32 v13, 14, v14
    v_and_b32 v15, 7, v0
    v_lshl_add_u32 v13, v15, 4, v13
    v_lshlrev_b32 v14, 5, v14
    v_add_u32 v14, 135936, v14
    v_lshlrev_b32 v37, 5, v11
    v_and_b32 v38, 16, v0
    v_add_u32 v37, v37, v38
    v_lshrrev_b32 v53, 5, v0
    v_lshl_add_u32 v37, v53, 13, v37
    s_mov_b32 s34, s5
    v_mov_b32 v35, s5
    s_mov_b32 s63, 0
L_flag16:
    ds_read_b32 v24, v25 offset:32
    s_add_u32 s63, s63, 1
    s_waitcnt lgkmcnt(0)
    v_cmp_gt_u32 vcc, 1, v24
    s_cbranch_vccz L_flag16_ok
    s_sleep 2
    s_cmp_lt_u32 s63, 2000000
    s_cbranch_scc1 L_flag16
L_flag16_ok:
    v_readfirstlane_b32 s80, v24
    s_nop 0
    s_and_b32 s81, s80, 7
    s_lshl_b32 s81, s81, 2
    s_lshr_b32 s81, 0x32108888, s81
    s_and_b32 s81, s81, 15
    s_lshl_b32 s29, s81, 1
    s_add_u32 s29, s29, s3
    s_sub_u32 s29, s29, 4
    s_lshl_b32 s56, s32, 17
    s_lshl_b32 s58, s29, 7
    s_add_u32 s58, s58, s56
    v_add_u32 v13, s58, v13
    s_and_b32 s57, s80, 3
    s_lshl_b32 s57, s57, 8
    s_add_u32 s57, s57, s56
    s_and_b32 s56, s3, 1
    s_lshl_b32 s56, s56, 16
    s_add_u32 s57, s57, s56
    s_setprio 0
    s_bitcmp1_b32 s80, 2
    s_cbranch_scc1 L_wt_a
    s_mov_b32 s63, 0
L_flag17:
    ds_read_b32 v24, v25 offset:4
    s_add_u32 s63, s63, 1
    s_waitcnt lgkmcnt(0)
    v_cmp_gt_u32 vcc, 4, v24
    s_cbranch_vccz L_flag17_ok
    s_sleep 2
    s_cmp_lt_u32 s63, 2000000
    s_cbranch_scc1 L_flag17
L_flag17_ok:
    buffer_load_dwordx4 v30, s[36:39], s57 offen nt lds
    s_add_u32 m0, m0, 1024
    s_addk_i32 s57, 4096
    buffer_load_dwordx4 v30, s[36:39], s57 offen nt lds
    s_add_u32 m0, m0, 1024
    s_addk_i32 s57, 4096
    buffer_load_dwordx4 v31, s[36:39], s57 offen nt lds
    s_add_u32 m0, m0, 1024
    s_addk_i32 s57, 4096
    buffer_load_dwordx4 v31, s[36:39], s57 offen nt lds
    s_add_u32 m0, m0, 1024
    s_addk_i32 s57, 4096
    buffer_load_dwordx4 v30, s[36:39], s57 offen nt lds
    s_add_u32 m0, m0, 1024
    s_addk_i32 s57, 4096
    buffer_load_dwordx4 v30, s[36:39], s57 offen nt lds
    s_add_u32 m0, m0, 1024
    s_addk_i32 s57, 4096
    buffer_load_dwordx4 v31, s[36:39], s57 offen nt lds
    s_add_u32 m0, m0, 1024
    s_addk_i32 s57, 4096
    buffer_load_dwordx4 v31, s[36:39], s57 offen nt lds
    s_add_u32 m0, m0, 1024
    s_addk_i32 s57, 4096
    buffer_load_dwordx4 v30, s[36:39], s57 offen nt lds
    s_add_u32 m0, m0, 1024
    s_addk_i32 s57, 4096
    buffer_load_dwordx4 v30, s[36:39], s57 offen nt lds
    s_add_u32 m0, m0, 1024
    s_addk_i32 s57, 4096
    buffer_load_dwordx4 v31, s[36:39], s57 offen nt lds
    s_add_u32 m0, m0, 1024
    s_addk_i32 s57, 4096
    buffer_load_dwordx4 v31, s[36:39], s57 offen nt lds
    s_add_u32 m0, m0, 1024
    s_addk_i32 s57, 4096
    buffer_load_dwordx4 v30, s[36:39], s57 offen nt lds
    s_add_u32 m0, m0, 1024
    s_addk_i32 s57, 4096
    buffer_load_dwordx4 v30, s[36:39], s57 offen nt lds
    s_add_u32 m0, m0, 1024
    s_addk_i32 s57, 4096
    buffer_load_dwordx4 v31, s[36:39], s57 offen nt lds
    s_add_u32 m0, m0, 1024
    s_addk_i32 s57, 4096
    buffer_load_dwordx4 v31, s[36:39], s57 offen nt lds
    s_waitcnt vmcnt(0)
    v_mov_b32 v24, 1
    s_mov_b64 exec, 1
    ds_add_u32 v25, v24 offset:52
    s_mov_b64 exec, -1
    s_branch L_fin
L_wt_a:
    s_cmp_eq_u32 s81, 8
    s_cbranch_scc1 L_fin
    s_mov_b32 s63, 0
L_flag18:
    ds_read_b32 v24, v25 offset:4
    s_add_u32 s63, s63, 1
    s_waitcnt lgkmcnt(0)
    v_cmp_gt_u32 vcc, 4, v24
    s_cbranch_vccz L_flag18_ok
    s_sleep 2
    s_cmp_lt_u32 s63, 2000000
    s_cbranch_scc1 L_flag18
L_flag18_ok:
    s_mov_b32 s56, 0
    buffer_load_dwordx4 v[128:131], v13, s[52:55], s56 offen offset:0 nt
    buffer_load_dwordx4 v[132:135], v13, s[52:55], s56 offen offset:1024 nt
    buffer_load_dwordx4 v[136:139], v13, s[52:55], s56 offen offset:2048 nt
    buffer_load_dwordx4 v[140:143], v13, s[52:55], s56 offen offset:3072 nt
    s_mov_b32 s56, 4096
    buffer_load_dwordx4 v[144:147], v13, s[52:55], s56 offen offset:0 nt
    buffer_load_dwordx4 v[148:151], v13, s[52:55], s56 offen offset:1024 nt
    buffer_load_dwordx4 v[152:155], v13, s[52:55], s56 offen offset:2048 nt
    buffer_load_dwordx4 v[156:159], v13, s[52:55], s56 offen offset:3072 nt
    s_mov_b32 s63, 0
L_flag19:
    ds_read_b32 v24, v25 offset:48
    s_add_u32 s63, s63, 1
    s_waitcnt lgkmcnt(0)
    v_cmp_gt_u32 vcc, 1, v24
    s_cbranch_vccz L_flag19_ok
    s_cmp_lt_u32 s63, 2000000
    s_cbranch_scc1 L_flag19
L_flag19_ok:
    s_mov_b32 s56, 8192
    buffer_load_dwordx4 v[160:163], v13, s[52:55], s56 offen offset:0 nt
    buffer_load_dwordx4 v[164:167], v13, s[52:55], s56 offen offset:1024 nt
    buffer_load_dwordx4 v[168:171], v13, s[52:55], s56 offen offset:2048 nt
    buffer_load_dwordx4 v[172:175], v13, s[52:55], s56 offen offset:3072 nt
    s_mov_b32 s56, 12288
    buffer_load_dwordx4 v[176:179], v13, s[52:55], s56 offen offset:0 nt
    buffer_load_dwordx4 v[180:183], v13, s[52:55], s56 offen offset:1024 nt
    buffer_load_dwordx4 v[184:187], v13, s[52:55], s56 offen offset:2048 nt
    buffer_load_dwordx4 v[188:191], v13, s[52:55], s56 offen offset:3072 nt
L_wt_a2:
    s_mov_b32 s48, s26
    s_mov_b32 s49, s27
    s_mov_b32 s50, 0x800
    s_mov_b32 s51, 0x20000
    s_mov_b32 s28, 1
    s_lshl_b32 s62, s29, 14
    s_add_u32 s62, s62, 917504
    s_lshl_b32 s61, s32, 8
    s_add_u32 s61, s61, s62
    s_lshl_b32 s58, s32, 3
    s_add_u32 s62, s62, s58
    v_lshrrev_b32 v53, 5, v0
    v_lshrrev_b32 v36, 3, v0
    v_lshlrev_b32 v36, 8, v36
    v_and_b32 v54, 7, v0
    v_lshl_add_u32 v36, v54, 4, v36
    v_lshlrev_b32 v54, 3, v54
    v_lshl_add_u32 v54, v53, 2, v54
    s_lshl_b32 s59, s29, 7
    s_lshl_b32 s58, s32, 2
    s_add_u32 s59, s59, s58
    ds_read_b32 v24, v25 offset:12
    s_waitcnt lgkmcnt(0)
    v_readfirstlane_b32 s56, v24
    s_nop 0
    s_add_u32 s62, s62, s56
    s_mov_b32 s63, 0
L_flag20:
    ds_read_b32 v24, v25 offset:40
    s_add_u32 s63, s63, 1
    s_waitcnt lgkmcnt(0)
    v_cmp_gt_u32 vcc, 1, v24
    s_cbranch_vccz L_flag20_ok
    s_sleep 1
    s_cmp_lt_u32 s63, 2000000
    s_cbranch_scc1 L_flag20
L_flag20_ok:
    ds_read_b128 v[16:19], v14
    ds_read_b128 v[20:23], v14 offset:16
    s_waitcnt lgkmcnt(0)
    v_perm_b32 v40, v16, v16, v1
    v_perm_b32 v41, v16, v16, v3
    v_perm_b32 v42, v16, v16, v5
    v_perm_b32 v43, v16, v16, v7
    v_perm_b32 v44, v16, v16, v2
    v_perm_b32 v45, v16, v16, v4
    v_perm_b32 v46, v16, v16, v6
    v_perm_b32 v47, v16, v16, v8
    s_waitcnt vmcnt(15)
    v_mfma_f32_16x16x32_bf16 v[28:31], v[40:43], v[128:131], 0
    v_perm_b32 v40, v17, v17, v1
    v_perm_b32 v41, v17, v17, v3
    v_perm_b32 v42, v17, v17, v5
    v_perm_b32 v43, v17, v17, v7
    s_waitcnt vmcnt(14)
    v_mfma_f32_16x16x32_bf16 v[28:31], v[44:47], v[132:135], v[28:31]
    v_perm_b32 v44, v17, v17, v2
    v_perm_b32 v45, v17, v17, v4
    v_perm_b32 v46, v17, v17, v6
    v_perm_b32 v47, v17, v17, v8
    s_waitcnt vmcnt(13)
    v_mfma_f32_16x16x32_bf16 v[28:31], v[40:43], v[136:139], v[28:31]
    v_perm_b32 v40, v18, v18, v1
    v_perm_b32 v41, v18, v18, v3
    v_perm_b32 v42, v18, v18, v5
    v_perm_b32 v43, v18, v18, v7
    s_waitcnt vmcnt(12)
    v_mfma_f32_16x16x32_bf16 v[28:31], v[44:47], v[140:143], v[28:31]
    v_perm_b32 v44, v18, v18, v2
    v_perm_b32 v45, v18, v18, v4
    v_perm_b32 v46, v18, v18, v6
    v_perm_b32 v47, v18, v18, v8
    s_waitcnt vmcnt(11)
    v_mfma_f32_16x16x32_bf16 v[28:31], v[40:43], v[144:147], v[28:31]
    v_perm_b32 v40, v19, v19, v1
    v_perm_b32 v41, v19, v19, v3
    v_perm_b32 v42, v19, v19, v5
    v_perm_b32 v43, v19, v19, v7
    s_waitcnt vmcnt(10)
    v_mfma_f32_16x16x32_bf16 v[28:31], v[44:47], v[148:151], v[28:31]
    v_perm_b32 v44, v19, v19, v2
    v_perm_b32 v45, v19, v19, v4
    v_perm_b32 v46, v19, v19, v6
    v_perm_b32 v47, v19, v19, v8
    s_waitcnt vmcnt(9)
    v_mfma_f32_16x16x32_bf16 v[28:31], v[40:43], v[152:155], v[28:31]
    v_perm_b32 v40, v20, v20, v1
    v_perm_b32 v41, v20, v20, v3
    v_perm_b32 v42, v20, v20, v5
    v_perm_b32 v43, v20, v20, v7
    s_waitcnt vmcnt(8)
    v_mfma_f32_16x16x32_bf16 v[28:31], v[44:47], v[156:159], v[28:31]
    v_perm_b32 v44, v20, v20, v2
    v_perm_b32 v45, v20, v20, v4
    v_perm_b32 v46, v20, v20, v6
    v_perm_b32 v47, v20, v20, v8
    s_waitcnt vmcnt(7)
    v_mfma_f32_16x16x32_bf16 v[28:31], v[40:43], v[160:163], v[28:31]
    v_perm_b32 v40, v21, v21, v1
    v_perm_b32 v41, v21, v21, v3
    v_perm_b32 v42, v21, v21, v5
    v_perm_b32 v43, v21, v21, v7
    s_waitcnt vmcnt(6)
    v_mfma_f32_16x16x32_bf16 v[28:31], v[44:47], v[164:167], v[28:31]
    v_perm_b32 v44, v21, v21, v2
    v_perm_b32 v45, v21, v21, v4
    v_perm_b32 v46, v21, v21, v6
    v_perm_b32 v47, v21, v21, v8
    s_waitcnt vmcnt(5)
    v_mfma_f32_16x16x32_bf16 v[28:31], v[40:43], v[168:171], v[28:31]
    v_perm_b32 v40, v22, v22, v1
    v_perm_b32 v41, v22, v22, v3
    v_perm_b32 v42, v22, v22, v5
    v_perm_b32 v43, v22, v22, v7
    s_waitcnt vmcnt(4)
    v_mfma_f32_16x16x32_bf16 v[28:31], v[44:47], v[172:175], v[28:31]
    v_perm_b32 v44, v22, v22, v2
    v_perm_b32 v45, v22, v22, v4
    v_perm_b32 v46, v22, v22, v6
    v_perm_b32 v47, v22, v22, v8
    s_waitcnt vmcnt(3)
    v_mfma_f32_16x16x32_bf16 v[28:31], v[40:43], v[176:179], v[28:31]
    v_perm_b32 v40, v23, v23, v1
    v_perm_b32 v41, v23, v23, v3
    v_perm_b32 v42, v23, v23, v5
    v_perm_b32 v43, v23, v23, v7
    s_waitcnt vmcnt(2)
    v_mfma_f32_16x16x32_bf16 v[28:31], v[44:47], v[180:183], v[28:31]
    v_perm_b32 v44, v23, v23, v2
    v_perm_b32 v45, v23, v23, v4
    v_perm_b32 v46, v23, v23, v6
    v_perm_b32 v47, v23, v23, v8
    s_waitcnt vmcnt(1)
    v_mfma_f32_16x16x32_bf16 v[28:31], v[40:43], v[184:187], v[28:31]
    s_waitcnt vmcnt(0)
    v_mfma_f32_16x16x32_bf16 v[28:31], v[44:47], v[188:191], v[28:31]
    s_nop 7
    v_mov_b32 v40, v28
    v_mov_b32 v41, v29
    v_mov_b32 v42, v30
    v_mov_b32 v43, v31
    v_permlane32_swap_b32 v28, v40
    v_permlane32_swap_b32 v29, v41
    v_permlane32_swap_b32 v30, v42
    v_permlane32_swap_b32 v31, v43
    v_add_f32_dpp v28, v40, v28 row_ror:8 row_mask:0xf bank_mask:0xf
    v_add_f32_dpp v29, v41, v29 row_ror:8 row_mask:0xf bank_mask:0xf
    v_add_f32_dpp v30, v42, v30 row_ror:8 row_mask:0xf bank_mask:0xf
    v_add_f32_dpp v31, v43, v31 row_ror:8 row_mask:0xf bank_mask:0xf
    v_perm_b32 v32, v28, v31, s8
    v_perm_b32 v33, v29, v31, s9
    v_perm_b32 v34, v30, v31, s10
    s_mov_b32 exec_lo, 0x00ff00ff
    s_mov_b32 exec_hi, 0x00ff00ff
    buffer_store_dwordx4 v[32:35], v37, s[44:47], s61 offen sc1
    s_mov_b64 exec, -1
    s_and_b32 s56, s32, 15
    s_cbranch_scc1 L_fin
L_wt_sum:
    s_add_u32 s61, s62, 4096
    s_mov_b32 s63, 0
    buffer_load_dwordx4 v[96:99], v36, s[44:47], s62 offen offset:0 sc1
    buffer_load_dwordx4 v[100:103], v36, s[44:47], s62 offen offset:2048 sc1
    buffer_load_dwordx4 v[104:107], v36, s[44:47], s61 offen offset:0 sc1
    buffer_load_dwordx4 v[108:111], v36, s[44:47], s61 offen offset:2048 sc1
L_poll21:
    s_waitcnt vmcnt(0)
    v_cmp_ne_u32 s[68:69], s34, v99
    v_cmp_ne_u32 s[70:71], s34, v103
    v_cmp_ne_u32 s[72:73], s34, v107
    v_cmp_ne_u32 s[74:75], s34, v111
    s_or_b64 vcc, s[68:69], s[70:71]
    s_or_b64 vcc, vcc, s[72:73]
    s_or_b64 vcc, vcc, s[74:75]
    s_cbranch_scc0 L_poll21_ok
    s_mov_b64 exec, s[68:69]
    buffer_load_dwordx4 v[96:99], v36, s[44:47], s62 offen offset:0 sc1
    s_mov_b64 exec, s[70:71]
    buffer_load_dwordx4 v[100:103], v36, s[44:47], s62 offen offset:2048 sc1
    s_mov_b64 exec, s[72:73]
    buffer_load_dwordx4 v[104:107], v36, s[44:47], s61 offen offset:0 sc1
    s_mov_b64 exec, s[74:75]
    buffer_load_dwordx4 v[108:111], v36, s[44:47], s61 offen offset:2048 sc1
    s_mov_b64 exec, -1
    s_add_u32 s63, s63, 1
    s_cmp_lt_u32 s63, 200000
    s_cbranch_scc1 L_poll21
    s_waitcnt vmcnt(0)
L_poll21_ok:
    v_perm_b32 v99, v97, v96, s11
    v_perm_b32 v103, v101, v100, s11
    v_perm_b32 v107, v105, v104, s11
    v_perm_b32 v111, v109, v108, s11
    v_lshl_or_b32 v99, v98, 24, v99
    v_lshl_or_b32 v103, v102, 24, v103
    v_lshl_or_b32 v107, v106, 24, v107
    v_lshl_or_b32 v111, v110, 24, v111
    v_pk_add_f32 v[96:97], v[96:97], v[100:101]
    v_pk_add_f32 v[98:99], v[98:99], v[102:103]
    v_pk_add_f32 v[104:105], v[104:105], v[108:109]
    v_pk_add_f32 v[106:107], v[106:107], v[110:111]
    v_pk_add_f32 v[96:97], v[96:97], v[104:105]
    v_pk_add_f32 v[98:99], v[98:99], v[106:107]
    s_nop 1
    v_permlane32_swap_b32 v96, v98
    v_permlane32_swap_b32 v97, v99
    v_add_f32 v96, v96, v98
    v_add_f32 v97, v97, v99
    s_nop 0
    v_add_f32_dpp v96, v96, v96 row_ror:8 row_mask:0xf bank_mask:0xf
    v_add_f32_dpp v97, v97, v97 row_ror:8 row_mask:0xf bank_mask:0xf
    v_mov_b32 v98, v96
    v_mov_b32 v99, v97
    s_nop 0
    v_permlane16_swap_b32 v96, v98
    v_permlane16_swap_b32 v97, v99
    v_add_f32 v96, v96, v98
    v_add_f32 v97, v97, v99
    v_cvt_pk_bf16_f32 v24, v96, v97
    s_mov_b32 exec_lo, 0xff
    s_mov_b32 exec_hi, 0xff
    buffer_store_dword v24, v54, s[48:51], s59 offen
    s_or_b32 s56, s32, s29
    s_cbranch_scc1 L_noepoch
    s_lshl_b32 s56, s28, 2
    s_mov_b64 exec, 1
    buffer_store_dword v35, v54, s[44:47], s56 offen offset:0
L_noepoch:
    s_mov_b64 exec, -1
    s_branch L_fin
L_stream:
    s_cmp_eq_u32 s33, 7
    s_cbranch_scc1 L_acu
    s_lshl_b32 s72, s32, 21
    s_lshl_b32 s56, s3, 12
    s_add_u32 s72, s72, s56
    s_mul_i32 s56, s32, 1
    s_and_b32 s56, s56, 15
    s_lshl_b32 s56, s56, 17
    s_add_u32 s72, s72, s56
    v_lshl_add_u32 v9, v9, 8, v10
    s_mov_b32 s71, s33
    s_lshl_b32 s56, s71, 14
    s_xor_b32 s61, s56, s72
    s_waitcnt lgkmcnt(0)
    s_mov_b32 s36, s18
    s_mov_b32 s37, s19
    s_mov_b32 s38, 0x4000000
    s_mov_b32 s39, 0x20000
    s_mov_b32 s40, s20
    s_mov_b32 s41, s21
    s_mov_b32 s42, 0x4000000
    s_mov_b32 s43, 0x20000
    s_barrier
    s_cmp_lt_u32 s33, 4
    s_cbranch_scc1 L_nocp
    s_mov_b32 s48, s6
    s_mov_b32 s49, s7
    s_mov_b32 s50, 0x800000
    s_mov_b32 s51, 0x20000
    s_sub_u32 s57, s32, s33
    s_add_u32 s57, s57, 7
    s_and_b32 s56, s57, 7
    s_lshl_b32 s56, s56, 19
    s_and_b32 s58, s57, 16
    s_lshl_b32 s58, s58, 18
    s_add_u32 s56, s56, s58
    s_and_b32 s58, s57, 8
    s_lshl_b32 s58, s58, 13
    s_add_u32 s56, s56, s58
    s_sub_u32 s58, s33, 3
    s_lshl_b32 s58, s58, 17
    s_add_u32 s56, s56, s58
    s_lshl_b32 s58, s3, 14
    s_add_u32 s56, s56, s58
    buffer_load_dwordx4 v[192:195], v26, s[48:51], s56 offen offset:0
    buffer_load_dwordx4 v[196:199], v26, s[48:51], s56 offen offset:1024
    buffer_load_dwordx4 v[200:203], v26, s[48:51], s56 offen offset:2048
    buffer_load_dwordx4 v[204:207], v26, s[48:51], s56 offen offset:3072
    s_addk_i32 s56, 4096
    buffer_load_dwordx4 v[208:211], v26, s[48:51], s56 offen offset:0
    buffer_load_dwordx4 v[212:215], v26, s[48:51], s56 offen offset:1024
    buffer_load_dwordx4 v[216:219], v26, s[48:51], s56 offen offset:2048
    buffer_load_dwordx4 v[220:223], v26, s[48:51], s56 offen offset:3072
    s_addk_i32 s56, 4096
    buffer_load_dwordx4 v[224:227], v26, s[48:51], s56 offen offset:0
    buffer_load_dwordx4 v[228:231], v26, s[48:51], s56 offen offset:1024
    buffer_load_dwordx4 v[232:235], v26, s[48:51], s56 offen offset:2048
    buffer_load_dwordx4 v[236:239], v26, s[48:51], s56 offen offset:3072
    s_addk_i32 s56, 4096
    buffer_load_dwordx4 v[240:243], v26, s[48:51], s56 offen offset:0
    buffer_load_dwordx4 v[244:247], v26, s[48:51], s56 offen offset:1024
    buffer_load_dwordx4 v[248:251], v26, s[48:51], s56 offen offset:2048
    buffer_load_dwordx4 v[252:255], v26, s[48:51], s56 offen offset:3072
    s_branch L_go
L_nocp:
    s_mov_b32 s48, s12
    s_mov_b32 s49, s13
    s_mov_b32 s50, 0x400000
    s_mov_b32 s51, 0x20000
    s_and_b32 s56, s33, 3
    s_mul_i32 s57, s56, 5
    s_xor_b32 s57, s57, s32
    s_lshl_b32 s57, s57, 8
    s_lshl_b32 s56, s56, 20
    s_add_u32 s57, s57, s56
    s_lshr_b32 s56, s3, 1
    s_lshl_b32 s56, s56, 19
    s_add_u32 s57, s57, s56
    s_and_b32 s56, s3, 1
    s_lshl_b32 s56, s56, 16
    s_add_u32 s57, s57, s56
    s_lshl_b32 s56, s3, 13
    s_add_u32 m0, s56, 67584
    v_lshlrev_b32 v13, 17, v12
    v_lshl_add_u32 v13, v11, 4, v13
    buffer_load_dwordx4 v13, s[48:51], s57 offen nt lds
    s_add_u32 m0, m0, 1024
    s_addk_i32 s57, 8192
    buffer_load_dwordx4 v13, s[48:51], s57 offen nt lds
    s_add_u32 m0, m0, 1024
    s_addk_i32 s57, 8192
    buffer_load_dwordx4 v13, s[48:51], s57 offen nt lds
    s_add_u32 m0, m0, 1024
    s_addk_i32 s57, 8192
    buffer_load_dwordx4 v13, s[48:51], s57 offen nt lds
    s_add_u32 m0, m0, 1024
    s_addk_i32 s57, 8192
    buffer_load_dwordx4 v13, s[48:51], s57 offen nt lds
    s_add_u32 m0, m0, 1024
    s_addk_i32 s57, 8192
    buffer_load_dwordx4 v13, s[48:51], s57 offen nt lds
    s_add_u32 m0, m0, 1024
    s_addk_i32 s57, 8192
    buffer_load_dwordx4 v13, s[48:51], s57 offen nt lds
    s_add_u32 m0, m0, 1024
    s_addk_i32 s57, 8192
    buffer_load_dwordx4 v13, s[48:51], s57 offen nt lds
L_go:
    buffer_load_dwordx4 v[64:67], v9, s[36:39], s61 offen offset:0 nt
    buffer_load_dwordx4 v[68:71], v9, s[36:39], s61 offen offset:1024 nt
    buffer_load_dwordx4 v[72:75], v9, s[36:39], s61 offen offset:2048 nt
    buffer_load_dwordx4 v[76:79], v9, s[36:39], s61 offen offset:3072 nt
    s_addk_i32 s71, 7
    s_lshl_b32 s56, s71, 14
    s_xor_b32 s61, s56, s72
    buffer_load_dwordx4 v[80:83], v9, s[36:39], s61 offen offset:0 nt
    buffer_load_dwordx4 v[84:87], v9, s[36:39], s61 offen offset:1024 nt
    v_and_b32 v13, 1, v0
    v_cmp_eq_u32 vcc, 1, v13
    v_mov_b32 v14, 0xc0c0100
    v_mov_b32 v1, 0x1000c0c
    v_cndmask_b32 v14, v14, v1, vcc
    v_mov_b32 v15, 0xc0c0302
    v_mov_b32 v1, 0x3020c0c
    v_cndmask_b32 v15, v15, v1, vcc
    v_bfe_u32 v13, v0, 1, 2
    v_cmp_eq_u32 vcc, 0, v13
    v_mov_b32 v1, 0x0c0c0c0c
    v_mov_b32 v2, 0x0c0c0c0c
    v_cndmask_b32 v1, v1, v14, vcc
    v_cndmask_b32 v2, v2, v15, vcc
    v_cmp_eq_u32 vcc, 1, v13
    v_mov_b32 v3, 0x0c0c0c0c
    v_mov_b32 v4, 0x0c0c0c0c
    v_cndmask_b32 v3, v3, v14, vcc
    v_cndmask_b32 v4, v4, v15, vcc
    v_cmp_eq_u32 vcc, 2, v13
    v_mov_b32 v5, 0x0c0c0c0c
    v_mov_b32 v6, 0x0c0c0c0c
    v_cndmask_b32 v5, v5, v14, vcc
    v_cndmask_b32 v6, v6, v15, vcc
    v_cmp_eq_u32 vcc, 3, v13
    v_mov_b32 v7, 0x0c0c0c0c
    v_mov_b32 v8, 0x0c0c0c0c
    v_cndmask_b32 v7, v7, v14, vcc
    v_cndmask_b32 v8, v8, v15, vcc
    v_mov_b32 v28, 0
    v_mov_b32 v29, 0
    v_mov_b32 v30, 0
    v_mov_b32 v31, 0
    v_mov_b32 v36, 0xff61b1e6
    v_mov_b32 v37, 0
    v_add_u32 v11, 135168, v10
    s_lshl_b32 s56, s3, 9
    s_add_u32 s56, s56, 140288
    v_add_u32 v16, s56, v26
    s_lshl_b32 s56, s3, 3
    s_add_u32 s56, s56, 139520
    v_mov_b32 v17, s56
    v_add_u32 v19, 64, v25
    v_mov_b32 v20, 1
    s_waitcnt vmcnt(5)
    buffer_load_dwordx4 v[88:91], v9, s[36:39], s61 offen offset:2048 nt
    s_waitcnt vmcnt(5)
    buffer_load_dwordx4 v[92:95], v9, s[36:39], s61 offen offset:3072 nt
    s_addk_i32 s71, 7
    s_lshl_b32 s56, s71, 14
    s_xor_b32 s61, s56, s72
    s_waitcnt vmcnt(5)
    buffer_load_dwordx4 v[96:99], v9, s[36:39], s61 offen offset:0 nt
    s_waitcnt vmcnt(5)
    buffer_load_dwordx4 v[100:103], v9, s[36:39], s61 offen offset:1024 nt
    s_waitcnt vmcnt(5)
    buffer_load_dwordx4 v[104:107], v9, s[36:39], s61 offen offset:2048 nt
    s_waitcnt vmcnt(5)
    buffer_load_dwordx4 v[108:111], v9, s[36:39], s61 offen offset:3072 nt
    s_addk_i32 s71, 7
    s_lshl_b32 s56, s71, 14
    s_xor_b32 s61, s56, s72
    s_waitcnt vmcnt(5)
    buffer_load_dwordx4 v[112:115], v9, s[36:39], s61 offen offset:0 nt
    s_waitcnt vmcnt(5)
    buffer_load_dwordx4 v[116:119], v9, s[36:39], s61 offen offset:1024 nt
    s_waitcnt vmcnt(5)
    buffer_load_dwordx4 v[120:123], v9, s[36:39], s61 offen offset:2048 nt
    s_waitcnt vmcnt(5)
    buffer_load_dwordx4 v[124:127], v9, s[36:39], s61 offen offset:3072 nt
    s_addk_i32 s71, 7
    s_lshl_b32 s56, s71, 14
    s_xor_b32 s61, s56, s72
    s_waitcnt vmcnt(5)
    buffer_load_dwordx4 v[128:131], v9, s[36:39], s61 offen offset:0 nt
    s_waitcnt vmcnt(5)
    buffer_load_dwordx4 v[132:135], v9, s[36:39], s61 offen offset:1024 nt
    s_waitcnt vmcnt(5)
    buffer_load_dwordx4 v[136:139], v9, s[36:39], s61 offen offset:2048 nt
    s_waitcnt vmcnt(5)
    buffer_load_dwordx4 v[140:143], v9, s[36:39], s61 offen offset:3072 nt
    s_addk_i32 s71, 7
    s_lshl_b32 s56, s71, 14
    s_xor_b32 s61, s56, s72
    s_waitcnt vmcnt(5)
    buffer_load_dwordx4 v[144:147], v9, s[36:39], s61 offen offset:0 nt
    s_waitcnt vmcnt(5)
    buffer_load_dwordx4 v[148:151], v9, s[36:39], s61 offen offset:1024 nt
    s_waitcnt vmcnt(5)
    buffer_load_dwordx4 v[152:155], v9, s[36:39], s61 offen offset:2048 nt
    s_waitcnt vmcnt(5)
    buffer_load_dwordx4 v[156:159], v9, s[36:39], s61 offen offset:3072 nt
    s_mov_b32 s63, 0
L_flag1:
    ds_read_b32 v39, v25 offset:0
    s_add_u32 s63, s63, 1
    s_waitcnt lgkmcnt(0)
    v_cmp_gt_u32 vcc, 1, v39
    s_cbranch_vccz L_flag1_ok
    s_sleep 1
    s_cmp_lt_u32 s63, 2000000
    s_cbranch_scc1 L_flag1
L_flag1_ok:
    ds_read_b128 v[12:15], v11
    s_waitcnt lgkmcnt(0)
    s_addk_i32 s71, 7
    s_lshl_b32 s56, s71, 14
    s_xor_b32 s61, s56, s72
    s_waitcnt vmcnt(5)
    buffer_load_dwordx4 v[160:163], v9, s[36:39], s61 offen offset:0 nt
    v_mfma_f32_16x16x32_bf16 v[48:51], v[64:67], v[12:15], 0
    v_mfma_f32_16x16x32_bf16 v[52:55], v[68:71], v[12:15], 0
    v_mfma_f32_16x16x32_bf16 v[56:59], v[72:75], v[12:15], 0
    v_mfma_f32_16x16x32_bf16 v[60:63], v[76:79], v[12:15], 0
    s_nop 4
    v_mov_b32_dpp v192, v48 quad_perm:[0,0,0,0] row_mask:0xf bank_mask:0xf
    v_mov_b32_dpp v193, v52 quad_perm:[0,0,0,0] row_mask:0xf bank_mask:0xf
    v_mov_b32_dpp v194, v56 quad_perm:[0,0,0,0] row_mask:0xf bank_mask:0xf
    v_mov_b32_dpp v195, v60 quad_perm:[0,0,0,0] row_mask:0xf bank_mask:0xf
    v_add_f32_dpp v192, v49, v192 quad_perm:[1,1,1,1] row_mask:0xf bank_mask:0xf
    v_add_f32_dpp v193, v53, v193 quad_perm:[1,1,1,1] row_mask:0xf bank_mask:0xf
    v_add_f32_dpp v194, v57, v194 quad_perm:[1,1,1,1] row_mask:0xf bank_mask:0xf
    v_add_f32_dpp v195, v61, v195 quad_perm:[1,1,1,1] row_mask:0xf bank_mask:0xf
    v_add_f32_dpp v192, v50, v192 quad_perm:[2,2,2,2] row_mask:0xf bank_mask:0xf
    v_add_f32_dpp v193, v54, v193 quad_perm:[2,2,2,2] row_mask:0xf bank_mask:0xf
    v_add_f32_dpp v194, v58, v194 quad_perm:[2,2,2,2] row_mask:0xf bank_mask:0xf
    v_add_f32_dpp v195, v62, v195 quad_perm:[2,2,2,2] row_mask:0xf bank_mask:0xf
    v_add_f32_dpp v192, v51, v192 quad_perm:[3,3,3,3] row_mask:0xf bank_mask:0xf
    v_add_f32_dpp v193, v55, v193 quad_perm:[3,3,3,3] row_mask:0xf bank_mask:0xf
    v_add_f32_dpp v194, v59, v194 quad_perm:[3,3,3,3] row_mask:0xf bank_mask:0xf
    v_add_f32_dpp v195, v63, v195 quad_perm:[3,3,3,3] row_mask:0xf bank_mask:0xf
    v_max3_f32 v36, v192, v193, v36
    v_max3_f32 v36, v194, v195, v36
    s_waitcnt vmcnt(5)
    buffer_load_dwordx4 v[164:167], v9, s[36:39], s61 offen offset:1024 nt
    v_mfma_f32_16x16x32_bf16 v[48:51], v[80:83], v[12:15], 0
    v_mfma_f32_16x16x32_bf16 v[52:55], v[84:87], v[12:15], 0
    v_mfma_f32_16x16x32_bf16 v[56:59], v[88:91], v[12:15], 0
    v_mfma_f32_16x16x32_bf16 v[60:63], v[92:95], v[12:15], 0
    s_nop 4
    v_mov_b32_dpp v196, v48 quad_perm:[0,0,0,0] row_mask:0xf bank_mask:0xf
    v_mov_b32_dpp v197, v52 quad_perm:[0,0,0,0] row_mask:0xf bank_mask:0xf
    v_mov_b32_dpp v198, v56 quad_perm:[0,0,0,0] row_mask:0xf bank_mask:0xf
    v_mov_b32_dpp v199, v60 quad_perm:[0,0,0,0] row_mask:0xf bank_mask:0xf
    v_add_f32_dpp v196, v49, v196 quad_perm:[1,1,1,1] row_mask:0xf bank_mask:0xf
    v_add_f32_dpp v197, v53, v197 quad_perm:[1,1,1,1] row_mask:0xf bank_mask:0xf
    v_add_f32_dpp v198, v57, v198 quad_perm:[1,1,1,1] row_mask:0xf bank_mask:0xf
    v_add_f32_dpp v199, v61, v199 quad_perm:[1,1,1,1] row_mask:0xf bank_mask:0xf
    v_add_f32_dpp v196, v50, v196 quad_perm:[2,2,2,2] row_mask:0xf bank_mask:0xf
    v_add_f32_dpp v197, v54, v197 quad_perm:[2,2,2,2] row_mask:0xf bank_mask:0xf
    v_add_f32_dpp v198, v58, v198 quad_perm:[2,2,2,2] row_mask:0xf bank_mask:0xf
    v_add_f32_dpp v199, v62, v199 quad_perm:[2,2,2,2] row_mask:0xf bank_mask:0xf
    v_add_f32_dpp v196, v51, v196 quad_perm:[3,3,3,3] row_mask:0xf bank_mask:0xf
    v_add_f32_dpp v197, v55, v197 quad_perm:[3,3,3,3] row_mask:0xf bank_mask:0xf
    v_add_f32_dpp v198, v59, v198 quad_perm:[3,3,3,3] row_mask:0xf bank_mask:0xf
    v_add_f32_dpp v199, v63, v199 quad_perm:[3,3,3,3] row_mask:0xf bank_mask:0xf
    v_max3_f32 v36, v196, v197, v36
    v_max3_f32 v36, v198, v199, v36
    s_waitcnt vmcnt(5)
    buffer_load_dwordx4 v[168:171], v9, s[36:39], s61 offen offset:2048 nt
    v_mfma_f32_16x16x32_bf16 v[48:51], v[96:99], v[12:15], 0
    v_mfma_f32_16x16x32_bf16 v[52:55], v[100:103], v[12:15], 0
    v_mfma_f32_16x16x32_bf16 v[56:59], v[104:107], v[12:15], 0
    v_mfma_f32_16x16x32_bf16 v[60:63], v[108:111], v[12:15], 0
    s_nop 4
    v_mov_b32_dpp v200, v48 quad_perm:[0,0,0,0] row_mask:0xf bank_mask:0xf
    v_mov_b32_dpp v201, v52 quad_perm:[0,0,0,0] row_mask:0xf bank_mask:0xf
    v_mov_b32_dpp v202, v56 quad_perm:[0,0,0,0] row_mask:0xf bank_mask:0xf
    v_mov_b32_dpp v203, v60 quad_perm:[0,0,0,0] row_mask:0xf bank_mask:0xf
    v_add_f32_dpp v200, v49, v200 quad_perm:[1,1,1,1] row_mask:0xf bank_mask:0xf
    v_add_f32_dpp v201, v53, v201 quad_perm:[1,1,1,1] row_mask:0xf bank_mask:0xf
    v_add_f32_dpp v202, v57, v202 quad_perm:[1,1,1,1] row_mask:0xf bank_mask:0xf
    v_add_f32_dpp v203, v61, v203 quad_perm:[1,1,1,1] row_mask:0xf bank_mask:0xf
    v_add_f32_dpp v200, v50, v200 quad_perm:[2,2,2,2] row_mask:0xf bank_mask:0xf
    v_add_f32_dpp v201, v54, v201 quad_perm:[2,2,2,2] row_mask:0xf bank_mask:0xf
    v_add_f32_dpp v202, v58, v202 quad_perm:[2,2,2,2] row_mask:0xf bank_mask:0xf
    v_add_f32_dpp v203, v62, v203 quad_perm:[2,2,2,2] row_mask:0xf bank_mask:0xf
    v_add_f32_dpp v200, v51, v200 quad_perm:[3,3,3,3] row_mask:0xf bank_mask:0xf
    v_add_f32_dpp v201, v55, v201 quad_perm:[3,3,3,3] row_mask:0xf bank_mask:0xf
    v_add_f32_dpp v202, v59, v202 quad_perm:[3,3,3,3] row_mask:0xf bank_mask:0xf
    v_add_f32_dpp v203, v63, v203 quad_perm:[3,3,3,3] row_mask:0xf bank_mask:0xf
    v_max3_f32 v36, v200, v201, v36
    v_max3_f32 v36, v202, v203, v36
    s_waitcnt vmcnt(5)
    buffer_load_dwordx4 v[172:175], v9, s[36:39], s61 offen offset:3072 nt
    v_mfma_f32_16x16x32_bf16 v[48:51], v[112:115], v[12:15], 0
    v_mfma_f32_16x16x32_bf16 v[52:55], v[116:119], v[12:15], 0
    v_mfma_f32_16x16x32_bf16 v[56:59], v[120:123], v[12:15], 0
    v_mfma_f32_16x16x32_bf16 v[60:63], v[124:127], v[12:15], 0
    s_nop 4
    v_mov_b32_dpp v204, v48 quad_perm:[0,0,0,0] row_mask:0xf bank_mask:0xf
    v_mov_b32_dpp v205, v52 quad_perm:[0,0,0,0] row_mask:0xf bank_mask:0xf
    v_mov_b32_dpp v206, v56 quad_perm:[0,0,0,0] row_mask:0xf bank_mask:0xf
    v_mov_b32_dpp v207, v60 quad_perm:[0,0,0,0] row_mask:0xf bank_mask:0xf
    v_add_f32_dpp v204, v49, v204 quad_perm:[1,1,1,1] row_mask:0xf bank_mask:0xf
    v_add_f32_dpp v205, v53, v205 quad_perm:[1,1,1,1] row_mask:0xf bank_mask:0xf
    v_add_f32_dpp v206, v57, v206 quad_perm:[1,1,1,1] row_mask:0xf bank_mask:0xf
    v_add_f32_dpp v207, v61, v207 quad_perm:[1,1,1,1] row_mask:0xf bank_mask:0xf
    v_add_f32_dpp v204, v50, v204 quad_perm:[2,2,2,2] row_mask:0xf bank_mask:0xf
    v_add_f32_dpp v205, v54, v205 quad_perm:[2,2,2,2] row_mask:0xf bank_mask:0xf
    v_add_f32_dpp v206, v58, v206 quad_perm:[2,2,2,2] row_mask:0xf bank_mask:0xf
    v_add_f32_dpp v207, v62, v207 quad_perm:[2,2,2,2] row_mask:0xf bank_mask:0xf
    v_add_f32_dpp v204, v51, v204 quad_perm:[3,3,3,3] row_mask:0xf bank_mask:0xf
    v_add_f32_dpp v205, v55, v205 quad_perm:[3,3,3,3] row_mask:0xf bank_mask:0xf
    v_add_f32_dpp v206, v59, v206 quad_perm:[3,3,3,3] row_mask:0xf bank_mask:0xf
    v_add_f32_dpp v207, v63, v207 quad_perm:[3,3,3,3] row_mask:0xf bank_mask:0xf
    v_max3_f32 v36, v204, v205, v36
    v_max3_f32 v36, v206, v207, v36
    s_addk_i32 s71, 7
    s_lshl_b32 s56, s71, 14
    s_xor_b32 s61, s56, s72
    s_waitcnt vmcnt(5)
    buffer_load_dwordx4 v[176:179], v9, s[36:39], s61 offen offset:0 nt
    v_mfma_f32_16x16x32_bf16 v[48:51], v[128:131], v[12:15], 0
    v_mfma_f32_16x16x32_bf16 v[52:55], v[132:135], v[12:15], 0
    v_mfma_f32_16x16x32_bf16 v[56:59], v[136:139], v[12:15], 0
    v_mfma_f32_16x16x32_bf16 v[60:63], v[140:143], v[12:15], 0
    s_nop 4
    v_mov_b32_dpp v208, v48 quad_perm:[0,0,0,0] row_mask:0xf bank_mask:0xf
    v_mov_b32_dpp v209, v52 quad_perm:[0,0,0,0] row_mask:0xf bank_mask:0xf
    v_mov_b32_dpp v210, v56 quad_perm:[0,0,0,0] row_mask:0xf bank_mask:0xf
    v_mov_b32_dpp v211, v60 quad_perm:[0,0,0,0] row_mask:0xf bank_mask:0xf
    v_add_f32_dpp v208, v49, v208 quad_perm:[1,1,1,1] row_mask:0xf bank_mask:0xf
    v_add_f32_dpp v209, v53, v209 quad_perm:[1,1,1,1] row_mask:0xf bank_mask:0xf
    v_add_f32_dpp v210, v57, v210 quad_perm:[1,1,1,1] row_mask:0xf bank_mask:0xf
    v_add_f32_dpp v211, v61, v211 quad_perm:[1,1,1,1] row_mask:0xf bank_mask:0xf
    v_add_f32_dpp v208, v50, v208 quad_perm:[2,2,2,2] row_mask:0xf bank_mask:0xf
    v_add_f32_dpp v209, v54, v209 quad_perm:[2,2,2,2] row_mask:0xf bank_mask:0xf
    v_add_f32_dpp v210, v58, v210 quad_perm:[2,2,2,2] row_mask:0xf bank_mask:0xf
    v_add_f32_dpp v211, v62, v211 quad_perm:[2,2,2,2] row_mask:0xf bank_mask:0xf
    v_add_f32_dpp v208, v51, v208 quad_perm:[3,3,3,3] row_mask:0xf bank_mask:0xf
    v_add_f32_dpp v209, v55, v209 quad_perm:[3,3,3,3] row_mask:0xf bank_mask:0xf
    v_add_f32_dpp v210, v59, v210 quad_perm:[3,3,3,3] row_mask:0xf bank_mask:0xf
    v_add_f32_dpp v211, v63, v211 quad_perm:[3,3,3,3] row_mask:0xf bank_mask:0xf
    v_max3_f32 v36, v208, v209, v36
    v_max3_f32 v36, v210, v211, v36
    s_waitcnt vmcnt(5)
    buffer_load_dwordx4 v[180:183], v9, s[36:39], s61 offen offset:1024 nt
    v_mfma_f32_16x16x32_bf16 v[48:51], v[144:147], v[12:15], 0
    v_mfma_f32_16x16x32_bf16 v[52:55], v[148:151], v[12:15], 0
    v_mfma_f32_16x16x32_bf16 v[56:59], v[152:155], v[12:15], 0
    v_mfma_f32_16x16x32_bf16 v[60:63], v[156:159], v[12:15], 0
    s_nop 4
    v_mov_b32_dpp v212, v48 quad_perm:[0,0,0,0] row_mask:0xf bank_mask:0xf
    v_mov_b32_dpp v213, v52 quad_perm:[0,0,0,0] row_mask:0xf bank_mask:0xf
    v_mov_b32_dpp v214, v56 quad_perm:[0,0,0,0] row_mask:0xf bank_mask:0xf
    v_mov_b32_dpp v215, v60 quad_perm:[0,0,0,0] row_mask:0xf bank_mask:0xf
    v_add_f32_dpp v212, v49, v212 quad_perm:[1,1,1,1] row_mask:0xf bank_mask:0xf
    v_add_f32_dpp v213, v53, v213 quad_perm:[1,1,1,1] row_mask:0xf bank_mask:0xf
    v_add_f32_dpp v214, v57, v214 quad_perm:[1,1,1,1] row_mask:0xf bank_mask:0xf
    v_add_f32_dpp v215, v61, v215 quad_perm:[1,1,1,1] row_mask:0xf bank_mask:0xf
    v_add_f32_dpp v212, v50, v212 quad_perm:[2,2,2,2] row_mask:0xf bank_mask:0xf
    v_add_f32_dpp v213, v54, v213 quad_perm:[2,2,2,2] row_mask:0xf bank_mask:0xf
    v_add_f32_dpp v214, v58, v214 quad_perm:[2,2,2,2] row_mask:0xf bank_mask:0xf
    v_add_f32_dpp v215, v62, v215 quad_perm:[2,2,2,2] row_mask:0xf bank_mask:0xf
    v_add_f32_dpp v212, v51, v212 quad_perm:[3,3,3,3] row_mask:0xf bank_mask:0xf
    v_add_f32_dpp v213, v55, v213 quad_perm:[3,3,3,3] row_mask:0xf bank_mask:0xf
    v_add_f32_dpp v214, v59, v214 quad_perm:[3,3,3,3] row_mask:0xf bank_mask:0xf
    v_add_f32_dpp v215, v63, v215 quad_perm:[3,3,3,3] row_mask:0xf bank_mask:0xf
    v_max3_f32 v36, v212, v213, v36
    v_max3_f32 v36, v214, v215, v36
    s_waitcnt vmcnt(5)
    buffer_load_dwordx4 v[184:187], v9, s[36:39], s61 offen offset:2048 nt
    s_waitcnt vmcnt(5)
    buffer_load_dwordx4 v[188:191], v9, s[36:39], s61 offen offset:3072 nt
    s_addk_i32 s71, 7
    s_lshl_b32 s56, s71, 14
    s_xor_b32 s61, s56, s72
    s_waitcnt vmcnt(5)
    buffer_load_dwordx4 v[64:67], v9, s[36:39], s61 offen offset:0 nt
    s_waitcnt vmcnt(5)
    buffer_load_dwordx4 v[68:71], v9, s[36:39], s61 offen offset:1024 nt
    v_mfma_f32_16x16x32_bf16 v[48:51], v[160:163], v[12:15], 0
    v_mfma_f32_16x16x32_bf16 v[52:55], v[164:167], v[12:15], 0
    v_mfma_f32_16x16x32_bf16 v[56:59], v[168:171], v[12:15], 0
    v_mfma_f32_16x16x32_bf16 v[60:63], v[172:175], v[12:15], 0
    s_nop 4
    v_mov_b32_dpp v216, v48 quad_perm:[0,0,0,0] row_mask:0xf bank_mask:0xf
    v_mov_b32_dpp v217, v52 quad_perm:[0,0,0,0] row_mask:0xf bank_mask:0xf
    v_mov_b32_dpp v218, v56 quad_perm:[0,0,0,0] row_mask:0xf bank_mask:0xf
    v_mov_b32_dpp v219, v60 quad_perm:[0,0,0,0] row_mask:0xf bank_mask:0xf
    v_add_f32_dpp v216, v49, v216 quad_perm:[1,1,1,1] row_mask:0xf bank_mask:0xf
    v_add_f32_dpp v217, v53, v217 quad_perm:[1,1,1,1] row_mask:0xf bank_mask:0xf
    v_add_f32_dpp v218, v57, v218 quad_perm:[1,1,1,1] row_mask:0xf bank_mask:0xf
    v_add_f32_dpp v219, v61, v219 quad_perm:[1,1,1,1] row_mask:0xf bank_mask:0xf
    v_add_f32_dpp v216, v50, v216 quad_perm:[2,2,2,2] row_mask:0xf bank_mask:0xf
    v_add_f32_dpp v217, v54, v217 quad_perm:[2,2,2,2] row_mask:0xf bank_mask:0xf
    v_add_f32_dpp v218, v58, v218 quad_perm:[2,2,2,2] row_mask:0xf bank_mask:0xf
    v_add_f32_dpp v219, v62, v219 quad_perm:[2,2,2,2] row_mask:0xf bank_mask:0xf
    v_add_f32_dpp v216, v51, v216 quad_perm:[3,3,3,3] row_mask:0xf bank_mask:0xf
    v_add_f32_dpp v217, v55, v217 quad_perm:[3,3,3,3] row_mask:0xf bank_mask:0xf
    v_add_f32_dpp v218, v59, v218 quad_perm:[3,3,3,3] row_mask:0xf bank_mask:0xf
    v_add_f32_dpp v219, v63, v219 quad_perm:[3,3,3,3] row_mask:0xf bank_mask:0xf
    v_max3_f32 v36, v216, v217, v36
    v_max3_f32 v36, v218, v219, v36
    s_waitcnt vmcnt(5)
    buffer_load_dwordx4 v[72:75], v9, s[36:39], s61 offen offset:2048 nt
    s_waitcnt vmcnt(5)
    buffer_load_dwordx4 v[76:79], v9, s[36:39], s61 offen offset:3072 nt
    s_addk_i32 s71, 7
    s_lshl_b32 s56, s71, 14
    s_xor_b32 s61, s56, s72
    s_waitcnt vmcnt(5)
    buffer_load_dwordx4 v[80:83], v9, s[36:39], s61 offen offset:0 nt
    s_waitcnt vmcnt(5)
    buffer_load_dwordx4 v[84:87], v9, s[36:39], s61 offen offset:1024 nt
    v_mfma_f32_16x16x32_bf16 v[48:51], v[176:179], v[12:15], 0
    v_mfma_f32_16x16x32_bf16 v[52:55], v[180:183], v[12:15], 0
    v_mfma_f32_16x16x32_bf16 v[56:59], v[184:187], v[12:15], 0
    v_mfma_f32_16x16x32_bf16 v[60:63], v[188:191], v[12:15], 0
    s_nop 4
    v_mov_b32_dpp v220, v48 quad_perm:[0,0,0,0] row_mask:0xf bank_mask:0xf
    v_mov_b32_dpp v221, v52 quad_perm:[0,0,0,0] row_mask:0xf bank_mask:0xf
    v_mov_b32_dpp v222, v56 quad_perm:[0,0,0,0] row_mask:0xf bank_mask:0xf
    v_mov_b32_dpp v223, v60 quad_perm:[0,0,0,0] row_mask:0xf bank_mask:0xf
    v_add_f32_dpp v220, v49, v220 quad_perm:[1,1,1,1] row_mask:0xf bank_mask:0xf
    v_add_f32_dpp v221, v53, v221 quad_perm:[1,1,1,1] row_mask:0xf bank_mask:0xf
    v_add_f32_dpp v222, v57, v222 quad_perm:[1,1,1,1] row_mask:0xf bank_mask:0xf
    v_add_f32_dpp v223, v61, v223 quad_perm:[1,1,1,1] row_mask:0xf bank_mask:0xf
    v_add_f32_dpp v220, v50, v220 quad_perm:[2,2,2,2] row_mask:0xf bank_mask:0xf
    v_add_f32_dpp v221, v54, v221 quad_perm:[2,2,2,2] row_mask:0xf bank_mask:0xf
    v_add_f32_dpp v222, v58, v222 quad_perm:[2,2,2,2] row_mask:0xf bank_mask:0xf
    v_add_f32_dpp v223, v62, v223 quad_perm:[2,2,2,2] row_mask:0xf bank_mask:0xf
    v_add_f32_dpp v220, v51, v220 quad_perm:[3,3,3,3] row_mask:0xf bank_mask:0xf
    v_add_f32_dpp v221, v55, v221 quad_perm:[3,3,3,3] row_mask:0xf bank_mask:0xf
    v_add_f32_dpp v222, v59, v222 quad_perm:[3,3,3,3] row_mask:0xf bank_mask:0xf
    v_add_f32_dpp v223, v63, v223 quad_perm:[3,3,3,3] row_mask:0xf bank_mask:0xf
    v_max3_f32 v36, v220, v221, v36
    v_max3_f32 v36, v222, v223, v36
    s_waitcnt vmcnt(5)
    buffer_load_dwordx4 v[88:91], v9, s[36:39], s61 offen offset:2048 nt
    s_waitcnt vmcnt(5)
    buffer_load_dwordx4 v[92:95], v9, s[36:39], s61 offen offset:3072 nt
    s_addk_i32 s71, 7
    s_lshl_b32 s56, s71, 14
    s_xor_b32 s61, s56, s72
    s_waitcnt vmcnt(5)
    buffer_load_dwordx4 v[96:99], v9, s[36:39], s61 offen offset:0 nt
    s_waitcnt vmcnt(5)
    buffer_load_dwordx4 v[100:103], v9, s[36:39], s61 offen offset:1024 nt
    v_mfma_f32_16x16x32_bf16 v[48:51], v[64:67], v[12:15], 0
    v_mfma_f32_16x16x32_bf16 v[52:55], v[68:71], v[12:15], 0
    v_mfma_f32_16x16x32_bf16 v[56:59], v[72:75], v[12:15], 0
    v_mfma_f32_16x16x32_bf16 v[60:63], v[76:79], v[12:15], 0
    s_nop 4
    v_mov_b32_dpp v224, v48 quad_perm:[0,0,0,0] row_mask:0xf bank_mask:0xf
    v_mov_b32_dpp v225, v52 quad_perm:[0,0,0,0] row_mask:0xf bank_mask:0xf
    v_mov_b32_dpp v226, v56 quad_perm:[0,0,0,0] row_mask:0xf bank_mask:0xf
    v_mov_b32_dpp v227, v60 quad_perm:[0,0,0,0] row_mask:0xf bank_mask:0xf
    v_add_f32_dpp v224, v49, v224 quad_perm:[1,1,1,1] row_mask:0xf bank_mask:0xf
    v_add_f32_dpp v225, v53, v225 quad_perm:[1,1,1,1] row_mask:0xf bank_mask:0xf
    v_add_f32_dpp v226, v57, v226 quad_perm:[1,1,1,1] row_mask:0xf bank_mask:0xf
    v_add_f32_dpp v227, v61, v227 quad_perm:[1,1,1,1] row_mask:0xf bank_mask:0xf
    v_add_f32_dpp v224, v50, v224 quad_perm:[2,2,2,2] row_mask:0xf bank_mask:0xf
    v_add_f32_dpp v225, v54, v225 quad_perm:[2,2,2,2] row_mask:0xf bank_mask:0xf
    v_add_f32_dpp v226, v58, v226 quad_perm:[2,2,2,2] row_mask:0xf bank_mask:0xf
    v_add_f32_dpp v227, v62, v227 quad_perm:[2,2,2,2] row_mask:0xf bank_mask:0xf
    v_add_f32_dpp v224, v51, v224 quad_perm:[3,3,3,3] row_mask:0xf bank_mask:0xf
    v_add_f32_dpp v225, v55, v225 quad_perm:[3,3,3,3] row_mask:0xf bank_mask:0xf
    v_add_f32_dpp v226, v59, v226 quad_perm:[3,3,3,3] row_mask:0xf bank_mask:0xf
    v_add_f32_dpp v227, v63, v227 quad_perm:[3,3,3,3] row_mask:0xf bank_mask:0xf
    v_max3_f32 v36, v224, v225, v36
    v_max3_f32 v36, v226, v227, v36
    s_waitcnt vmcnt(5)
    buffer_load_dwordx4 v[104:107], v9, s[36:39], s61 offen offset:2048 nt
    s_waitcnt vmcnt(5)
    buffer_load_dwordx4 v[108:111], v9, s[36:39], s61 offen offset:3072 nt
    s_addk_i32 s71, 7
    s_lshl_b32 s56, s71, 14
    s_xor_b32 s61, s56, s72
    s_waitcnt vmcnt(5)
    buffer_load_dwordx4 v[112:115], v9, s[36:39], s61 offen offset:0 nt
    s_waitcnt vmcnt(5)
    buffer_load_dwordx4 v[116:119], v9, s[36:39], s61 offen offset:1024 nt
    v_mfma_f32_16x16x32_bf16 v[48:51], v[80:83], v[12:15], 0
    v_mfma_f32_16x16x32_bf16 v[52:55], v[84:87], v[12:15], 0
    v_mfma_f32_16x16x32_bf16 v[56:59], v[88:91], v[12:15], 0
    v_mfma_f32_16x16x32_bf16 v[60:63], v[92:95], v[12:15], 0
    s_nop 4
    v_mov_b32_dpp v228, v48 quad_perm:[0,0,0,0] row_mask:0xf bank_mask:0xf
    v_mov_b32_dpp v229, v52 quad_perm:[0,0,0,0] row_mask:0xf bank_mask:0xf
    v_mov_b32_dpp v230, v56 quad_perm:[0,0,0,0] row_mask:0xf bank_mask:0xf
    v_mov_b32_dpp v231, v60 quad_perm:[0,0,0,0] row_mask:0xf bank_mask:0xf
    v_add_f32_dpp v228, v49, v228 quad_perm:[1,1,1,1] row_mask:0xf bank_mask:0xf
    v_add_f32_dpp v229, v53, v229 quad_perm:[1,1,1,1] row_mask:0xf bank_mask:0xf
    v_add_f32_dpp v230, v57, v230 quad_perm:[1,1,1,1] row_mask:0xf bank_mask:0xf
    v_add_f32_dpp v231, v61, v231 quad_perm:[1,1,1,1] row_mask:0xf bank_mask:0xf
    v_add_f32_dpp v228, v50, v228 quad_perm:[2,2,2,2] row_mask:0xf bank_mask:0xf
    v_add_f32_dpp v229, v54, v229 quad_perm:[2,2,2,2] row_mask:0xf bank_mask:0xf
    v_add_f32_dpp v230, v58, v230 quad_perm:[2,2,2,2] row_mask:0xf bank_mask:0xf
    v_add_f32_dpp v231, v62, v231 quad_perm:[2,2,2,2] row_mask:0xf bank_mask:0xf
    v_add_f32_dpp v228, v51, v228 quad_perm:[3,3,3,3] row_mask:0xf bank_mask:0xf
    v_add_f32_dpp v229, v55, v229 quad_perm:[3,3,3,3] row_mask:0xf bank_mask:0xf
    v_add_f32_dpp v230, v59, v230 quad_perm:[3,3,3,3] row_mask:0xf bank_mask:0xf
    v_add_f32_dpp v231, v63, v231 quad_perm:[3,3,3,3] row_mask:0xf bank_mask:0xf
    v_max3_f32 v36, v228, v229, v36
    v_max3_f32 v36, v230, v231, v36
    s_waitcnt vmcnt(5)
    buffer_load_dwordx4 v[120:123], v9, s[36:39], s61 offen offset:2048 nt
    s_waitcnt vmcnt(5)
    buffer_load_dwordx4 v[124:127], v9, s[36:39], s61 offen offset:3072 nt
    s_addk_i32 s71, 7
    s_lshl_b32 s56, s71, 14
    s_xor_b32 s61, s56, s72
    s_waitcnt vmcnt(5)
    buffer_load_dwordx4 v[128:131], v9, s[36:39], s61 offen offset:0 nt
    s_waitcnt vmcnt(5)
    buffer_load_dwordx4 v[132:135], v9, s[36:39], s61 offen offset:1024 nt
    v_mfma_f32_16x16x32_bf16 v[48:51], v[96:99], v[12:15], 0
    v_mfma_f32_16x16x32_bf16 v[52:55], v[100:103], v[12:15], 0
    v_mfma_f32_16x16x32_bf16 v[56:59], v[104:107], v[12:15], 0
    v_mfma_f32_16x16x32_bf16 v[60:63], v[108:111], v[12:15], 0
    s_nop 4
    v_mov_b32_dpp v232, v48 quad_perm:[0,0,0,0] row_mask:0xf bank_mask:0xf
    v_mov_b32_dpp v233, v52 quad_perm:[0,0,0,0] row_mask:0xf bank_mask:0xf
    v_mov_b32_dpp v234, v56 quad_perm:[0,0,0,0] row_mask:0xf bank_mask:0xf
    v_mov_b32_dpp v235, v60 quad_perm:[0,0,0,0] row_mask:0xf bank_mask:0xf
    v_add_f32_dpp v232, v49, v232 quad_perm:[1,1,1,1] row_mask:0xf bank_mask:0xf
    v_add_f32_dpp v233, v53, v233 quad_perm:[1,1,1,1] row_mask:0xf bank_mask:0xf
    v_add_f32_dpp v234, v57, v234 quad_perm:[1,1,1,1] row_mask:0xf bank_mask:0xf
    v_add_f32_dpp v235, v61, v235 quad_perm:[1,1,1,1] row_mask:0xf bank_mask:0xf
    v_add_f32_dpp v232, v50, v232 quad_perm:[2,2,2,2] row_mask:0xf bank_mask:0xf
    v_add_f32_dpp v233, v54, v233 quad_perm:[2,2,2,2] row_mask:0xf bank_mask:0xf
    v_add_f32_dpp v234, v58, v234 quad_perm:[2,2,2,2] row_mask:0xf bank_mask:0xf
    v_add_f32_dpp v235, v62, v235 quad_perm:[2,2,2,2] row_mask:0xf bank_mask:0xf
    v_add_f32_dpp v232, v51, v232 quad_perm:[3,3,3,3] row_mask:0xf bank_mask:0xf
    v_add_f32_dpp v233, v55, v233 quad_perm:[3,3,3,3] row_mask:0xf bank_mask:0xf
    v_add_f32_dpp v234, v59, v234 quad_perm:[3,3,3,3] row_mask:0xf bank_mask:0xf
    v_add_f32_dpp v235, v63, v235 quad_perm:[3,3,3,3] row_mask:0xf bank_mask:0xf
    v_max3_f32 v36, v232, v233, v36
    v_max3_f32 v36, v234, v235, v36
    s_waitcnt vmcnt(5)
    buffer_load_dwordx4 v[136:139], v9, s[36:39], s61 offen offset:2048 nt
    s_waitcnt vmcnt(5)
    buffer_load_dwordx4 v[140:143], v9, s[36:39], s61 offen offset:3072 nt
    s_addk_i32 s71, 7
    s_lshl_b32 s56, s71, 14
    s_xor_b32 s61, s56, s72
    s_waitcnt vmcnt(5)
    buffer_load_dwordx4 v[144:147], v9, s[36:39], s61 offen offset:0 nt
    s_waitcnt vmcnt(5)
    buffer_load_dwordx4 v[148:151], v9, s[36:39], s61 offen offset:1024 nt
    v_mfma_f32_16x16x32_bf16 v[48:51], v[112:115], v[12:15], 0
    v_mfma_f32_16x16x32_bf16 v[52:55], v[116:119], v[12:15], 0
    v_mfma_f32_16x16x32_bf16 v[56:59], v[120:123], v[12:15], 0
    v_mfma_f32_16x16x32_bf16 v[60:63], v[124:127], v[12:15], 0
    s_nop 4
    v_mov_b32_dpp v236, v48 quad_perm:[0,0,0,0] row_mask:0xf bank_mask:0xf
    v_mov_b32_dpp v237, v52 quad_perm:[0,0,0,0] row_mask:0xf bank_mask:0xf
    v_mov_b32_dpp v238, v56 quad_perm:[0,0,0,0] row_mask:0xf bank_mask:0xf
    v_mov_b32_dpp v239, v60 quad_perm:[0,0,0,0] row_mask:0xf bank_mask:0xf
    v_add_f32_dpp v236, v49, v236 quad_perm:[1,1,1,1] row_mask:0xf bank_mask:0xf
    v_add_f32_dpp v237, v53, v237 quad_perm:[1,1,1,1] row_mask:0xf bank_mask:0xf
    v_add_f32_dpp v238, v57, v238 quad_perm:[1,1,1,1] row_mask:0xf bank_mask:0xf
    v_add_f32_dpp v239, v61, v239 quad_perm:[1,1,1,1] row_mask:0xf bank_mask:0xf
    v_add_f32_dpp v236, v50, v236 quad_perm:[2,2,2,2] row_mask:0xf bank_mask:0xf
    v_add_f32_dpp v237, v54, v237 quad_perm:[2,2,2,2] row_mask:0xf bank_mask:0xf
    v_add_f32_dpp v238, v58, v238 quad_perm:[2,2,2,2] row_mask:0xf bank_mask:0xf
    v_add_f32_dpp v239, v62, v239 quad_perm:[2,2,2,2] row_mask:0xf bank_mask:0xf
    v_add_f32_dpp v236, v51, v236 quad_perm:[3,3,3,3] row_mask:0xf bank_mask:0xf
    v_add_f32_dpp v237, v55, v237 quad_perm:[3,3,3,3] row_mask:0xf bank_mask:0xf
    v_add_f32_dpp v238, v59, v238 quad_perm:[3,3,3,3] row_mask:0xf bank_mask:0xf
    v_add_f32_dpp v239, v63, v239 quad_perm:[3,3,3,3] row_mask:0xf bank_mask:0xf
    v_max3_f32 v36, v236, v237, v36
    v_max3_f32 v36, v238, v239, v36
    s_waitcnt vmcnt(5)
    buffer_load_dwordx4 v[152:155], v9, s[36:39], s61 offen offset:2048 nt
    s_waitcnt vmcnt(5)
    buffer_load_dwordx4 v[156:159], v9, s[36:39], s61 offen offset:3072 nt
    s_addk_i32 s71, -91
    s_lshl_b32 s56, s71, 14
    s_xor_b32 s61, s56, s72
    s_waitcnt vmcnt(5)
    buffer_load_dwordx4 v[160:163], v26, s[40:43], s61 offen offset:0 nt
    s_waitcnt vmcnt(5)
    buffer_load_dwordx4 v[164:167], v26, s[40:43], s61 offen offset:1024 nt
    v_mfma_f32_16x16x32_bf16 v[48:51], v[128:131], v[12:15], 0
    v_mfma_f32_16x16x32_bf16 v[52:55], v[132:135], v[12:15], 0
    v_mfma_f32_16x16x32_bf16 v[56:59], v[136:139], v[12:15], 0
    v_mfma_f32_16x16x32_bf16 v[60:63], v[140:143], v[12:15], 0
    s_nop 4
    v_mov_b32_dpp v240, v48 quad_perm:[0,0,0,0] row_mask:0xf bank_mask:0xf
    v_mov_b32_dpp v241, v52 quad_perm:[0,0,0,0] row_mask:0xf bank_mask:0xf
    v_mov_b32_dpp v242, v56 quad_perm:[0,0,0,0] row_mask:0xf bank_mask:0xf
    v_mov_b32_dpp v243, v60 quad_perm:[0,0,0,0] row_mask:0xf bank_mask:0xf
    v_add_f32_dpp v240, v49, v240 quad_perm:[1,1,1,1] row_mask:0xf bank_mask:0xf
    v_add_f32_dpp v241, v53, v241 quad_perm:[1,1,1,1] row_mask:0xf bank_mask:0xf
    v_add_f32_dpp v242, v57, v242 quad_perm:[1,1,1,1] row_mask:0xf bank_mask:0xf
    v_add_f32_dpp v243, v61, v243 quad_perm:[1,1,1,1] row_mask:0xf bank_mask:0xf
    v_add_f32_dpp v240, v50, v240 quad_perm:[2,2,2,2] row_mask:0xf bank_mask:0xf
    v_add_f32_dpp v241, v54, v241 quad_perm:[2,2,2,2] row_mask:0xf bank_mask:0xf
    v_add_f32_dpp v242, v58, v242 quad_perm:[2,2,2,2] row_mask:0xf bank_mask:0xf
    v_add_f32_dpp v243, v62, v243 quad_perm:[2,2,2,2] row_mask:0xf bank_mask:0xf
    v_add_f32_dpp v240, v51, v240 quad_perm:[3,3,3,3] row_mask:0xf bank_mask:0xf
    v_add_f32_dpp v241, v55, v241 quad_perm:[3,3,3,3] row_mask:0xf bank_mask:0xf
    v_add_f32_dpp v242, v59, v242 quad_perm:[3,3,3,3] row_mask:0xf bank_mask:0xf
    v_add_f32_dpp v243, v63, v243 quad_perm:[3,3,3,3] row_mask:0xf bank_mask:0xf
    v_max3_f32 v36, v240, v241, v36
    v_max3_f32 v36, v242, v243, v36
    s_waitcnt vmcnt(5)
    buffer_load_dwordx4 v[168:171], v26, s[40:43], s61 offen offset:2048 nt
    s_waitcnt vmcnt(5)
    buffer_load_dwordx4 v[172:175], v26, s[40:43], s61 offen offset:3072 nt
    s_addk_i32 s71, 7
    s_lshl_b32 s56, s71, 14
    s_xor_b32 s61, s56, s72
    s_waitcnt vmcnt(5)
    buffer_load_dwordx4 v[176:179], v26, s[40:43], s61 offen offset:0 nt
    s_waitcnt vmcnt(5)
    buffer_load_dwordx4 v[180:183], v26, s[40:43], s61 offen offset:1024 nt
    v_mfma_f32_16x16x32_bf16 v[48:51], v[144:147], v[12:15], 0
    v_mfma_f32_16x16x32_bf16 v[52:55], v[148:151], v[12:15], 0
    v_mfma_f32_16x16x32_bf16 v[56:59], v[152:155], v[12:15], 0
    v_mfma_f32_16x16x32_bf16 v[60:63], v[156:159], v[12:15], 0
    s_nop 4
    v_mov_b32_dpp v244, v48 quad_perm:[0,0,0,0] row_mask:0xf bank_mask:0xf
    v_mov_b32_dpp v245, v52 quad_perm:[0,0,0,0] row_mask:0xf bank_mask:0xf
    v_mov_b32_dpp v246, v56 quad_perm:[0,0,0,0] row_mask:0xf bank_mask:0xf
    v_mov_b32_dpp v247, v60 quad_perm:[0,0,0,0] row_mask:0xf bank_mask:0xf
    v_add_f32_dpp v244, v49, v244 quad_perm:[1,1,1,1] row_mask:0xf bank_mask:0xf
    v_add_f32_dpp v245, v53, v245 quad_perm:[1,1,1,1] row_mask:0xf bank_mask:0xf
    v_add_f32_dpp v246, v57, v246 quad_perm:[1,1,1,1] row_mask:0xf bank_mask:0xf
    v_add_f32_dpp v247, v61, v247 quad_perm:[1,1,1,1] row_mask:0xf bank_mask:0xf
    v_add_f32_dpp v244, v50, v244 quad_perm:[2,2,2,2] row_mask:0xf bank_mask:0xf
    v_add_f32_dpp v245, v54, v245 quad_perm:[2,2,2,2] row_mask:0xf bank_mask:0xf
    v_add_f32_dpp v246, v58, v246 quad_perm:[2,2,2,2] row_mask:0xf bank_mask:0xf
    v_add_f32_dpp v247, v62, v247 quad_perm:[2,2,2,2] row_mask:0xf bank_mask:0xf
    v_add_f32_dpp v244, v51, v244 quad_perm:[3,3,3,3] row_mask:0xf bank_mask:0xf
    v_add_f32_dpp v245, v55, v245 quad_perm:[3,3,3,3] row_mask:0xf bank_mask:0xf
    v_add_f32_dpp v246, v59, v246 quad_perm:[3,3,3,3] row_mask:0xf bank_mask:0xf
    v_add_f32_dpp v247, v63, v247 quad_perm:[3,3,3,3] row_mask:0xf bank_mask:0xf
    v_max3_f32 v36, v244, v245, v36
    v_max3_f32 v36, v246, v247, v36
    v_mov_b32 v39, v36
    s_nop 1
    v_permlane32_swap_b32 v36, v39
    v_max_f32 v36, v36, v39
    v_mov_b32 v39, v36
    s_nop 1
    v_permlane16_swap_b32 v36, v39
    v_max_f32 v36, v36, v39
    v_mul_f32 v41, s60, v36
    v_fma_f32 v42, v192, s60, -v41
    v_fma_f32 v43, v193, s60, -v41
    v_fma_f32 v44, v194, s60, -v41
    v_fma_f32 v45, v195, s60, -v41
    v_exp_f32 v42, v42
    v_exp_f32 v43, v43
    v_exp_f32 v44, v44
    v_exp_f32 v45, v45
    v_add_f32 v37, v37, v42
    v_cvt_pk_bf16_f32 v46, v42, v43
    v_cvt_pk_bf16_f32 v47, v44, v45
    v_add_f32 v43, v43, v44
    v_add_f32 v37, v37, v45
    v_add_f32 v37, v37, v43
    v_perm_b32 v48, v46, v46, v1
    v_perm_b32 v49, v46, v46, v3
    v_perm_b32 v50, v46, v46, v5
    v_perm_b32 v51, v46, v46, v7
    v_perm_b32 v52, v46, v46, v2
    v_perm_b32 v53, v46, v46, v4
    v_perm_b32 v54, v46, v46, v6
    v_perm_b32 v55, v46, v46, v8
    v_perm_b32 v56, v47, v47, v1
    v_perm_b32 v57, v47, v47, v3
    v_perm_b32 v58, v47, v47, v5
    v_perm_b32 v59, v47, v47, v7
    v_perm_b32 v60, v47, v47, v2
    v_perm_b32 v61, v47, v47, v4
    v_perm_b32 v62, v47, v47, v6
    v_perm_b32 v63, v47, v47, v8
    s_waitcnt vmcnt(5)
    buffer_load_dwordx4 v[184:187], v26, s[40:43], s61 offen offset:2048 nt
    v_mfma_f32_16x16x32_bf16 v[28:31], v[48:51], v[160:163], v[28:31]
    s_waitcnt vmcnt(5)
    buffer_load_dwordx4 v[188:191], v26, s[40:43], s61 offen offset:3072 nt
    v_mfma_f32_16x16x32_bf16 v[28:31], v[52:55], v[164:167], v[28:31]
    s_addk_i32 s71, 7
    s_lshl_b32 s56, s71, 14
    s_xor_b32 s61, s56, s72
    s_waitcnt vmcnt(5)
    buffer_load_dwordx4 v[64:67], v26, s[40:43], s61 offen offset:0 nt
    v_mfma_f32_16x16x32_bf16 v[28:31], v[56:59], v[168:171], v[28:31]
    s_waitcnt vmcnt(5)
    buffer_load_dwordx4 v[68:71], v26, s[40:43], s61 offen offset:1024 nt
    v_mfma_f32_16x16x32_bf16 v[28:31], v[60:63], v[172:175], v[28:31]
    v_fma_f32 v42, v196, s60, -v41
    v_fma_f32 v43, v197, s60, -v41
    v_fma_f32 v44, v198, s60, -v41
    v_fma_f32 v45, v199, s60, -v41
    v_exp_f32 v42, v42
    v_exp_f32 v43, v43
    v_exp_f32 v44, v44
    v_exp_f32 v45, v45
    v_add_f32 v37, v37, v42
    v_cvt_pk_bf16_f32 v46, v42, v43
    v_cvt_pk_bf16_f32 v47, v44, v45
    v_add_f32 v43, v43, v44
    v_add_f32 v37, v37, v45
    v_add_f32 v37, v37, v43
    v_perm_b32 v48, v46, v46, v1
    v_perm_b32 v49, v46, v46, v3
    v_perm_b32 v50, v46, v46, v5
    v_perm_b32 v51, v46, v46, v7
    v_perm_b32 v52, v46, v46, v2
    v_perm_b32 v53, v46, v46, v4
    v_perm_b32 v54, v46, v46, v6
    v_perm_b32 v55, v46, v46, v8
    v_perm_b32 v56, v47, v47, v1
    v_perm_b32 v57, v47, v47, v3
    v_perm_b32 v58, v47, v47, v5
    v_perm_b32 v59, v47, v47, v7
    v_perm_b32 v60, v47, v47, v2
    v_perm_b32 v61, v47, v47, v4
    v_perm_b32 v62, v47, v47, v6
    v_perm_b32 v63, v47, v47, v8
    s_waitcnt vmcnt(5)
    buffer_load_dwordx4 v[72:75], v26, s[40:43], s61 offen offset:2048 nt
    v_mfma_f32_16x16x32_bf16 v[28:31], v[48:51], v[176:179], v[28:31]
    s_waitcnt vmcnt(5)
    buffer_load_dwordx4 v[76:79], v26, s[40:43], s61 offen offset:3072 nt
    v_mfma_f32_16x16x32_bf16 v[28:31], v[52:55], v[180:183], v[28:31]
    s_addk_i32 s71, 7
    s_lshl_b32 s56, s71, 14
    s_xor_b32 s61, s56, s72
    s_waitcnt vmcnt(5)
    buffer_load_dwordx4 v[80:83], v26, s[40:43], s61 offen offset:0 nt
    v_mfma_f32_16x16x32_bf16 v[28:31], v[56:59], v[184:187], v[28:31]
    s_waitcnt vmcnt(5)
    buffer_load_dwordx4 v[84:87], v26, s[40:43], s61 offen offset:1024 nt
    v_mfma_f32_16x16x32_bf16 v[28:31], v[60:63], v[188:191], v[28:31]
    v_fma_f32 v42, v200, s60, -v41
    v_fma_f32 v43, v201, s60, -v41
    v_fma_f32 v44, v202, s60, -v41
    v_fma_f32 v45, v203, s60, -v41
    v_exp_f32 v42, v42
    v_exp_f32 v43, v43
    v_exp_f32 v44, v44
    v_exp_f32 v45, v45
    v_add_f32 v37, v37, v42
    v_cvt_pk_bf16_f32 v46, v42, v43
    v_cvt_pk_bf16_f32 v47, v44, v45
    v_add_f32 v43, v43, v44
    v_add_f32 v37, v37, v45
    v_add_f32 v37, v37, v43
    v_perm_b32 v48, v46, v46, v1
    v_perm_b32 v49, v46, v46, v3
    v_perm_b32 v50, v46, v46, v5
    v_perm_b32 v51, v46, v46, v7
    v_perm_b32 v52, v46, v46, v2
    v_perm_b32 v53, v46, v46, v4
    v_perm_b32 v54, v46, v46, v6
    v_perm_b32 v55, v46, v46, v8
    v_perm_b32 v56, v47, v47, v1
    v_perm_b32 v57, v47, v47, v3
    v_perm_b32 v58, v47, v47, v5
    v_perm_b32 v59, v47, v47, v7
    v_perm_b32 v60, v47, v47, v2
    v_perm_b32 v61, v47, v47, v4
    v_perm_b32 v62, v47, v47, v6
    v_perm_b32 v63, v47, v47, v8
    s_waitcnt vmcnt(5)
    buffer_load_dwordx4 v[88:91], v26, s[40:43], s61 offen offset:2048 nt
    v_mfma_f32_16x16x32_bf16 v[28:31], v[48:51], v[64:67], v[28:31]
    s_waitcnt vmcnt(5)
    buffer_load_dwordx4 v[92:95], v26, s[40:43], s61 offen offset:3072 nt
    v_mfma_f32_16x16x32_bf16 v[28:31], v[52:55], v[68:71], v[28:31]
    s_addk_i32 s71, 7
    s_lshl_b32 s56, s71, 14
    s_xor_b32 s61, s56, s72
    s_waitcnt vmcnt(5)
    buffer_load_dwordx4 v[96:99], v26, s[40:43], s61 offen offset:0 nt
    v_mfma_f32_16x16x32_bf16 v[28:31], v[56:59], v[72:75], v[28:31]
    s_waitcnt vmcnt(5)
    buffer_load_dwordx4 v[100:103], v26, s[40:43], s61 offen offset:1024 nt
    v_mfma_f32_16x16x32_bf16 v[28:31], v[60:63], v[76:79], v[28:31]
    v_fma_f32 v42, v204, s60, -v41
    v_fma_f32 v43, v205, s60, -v41
    v_fma_f32 v44, v206, s60, -v41
    v_fma_f32 v45, v207, s60, -v41
    v_exp_f32 v42, v42
    v_exp_f32 v43, v43
    v_exp_f32 v44, v44
    v_exp_f32 v45, v45
    v_add_f32 v37, v37, v42
    v_cvt_pk_bf16_f32 v46, v42, v43
    v_cvt_pk_bf16_f32 v47, v44, v45
    v_add_f32 v43, v43, v44
    v_add_f32 v37, v37, v45
    v_add_f32 v37, v37, v43
    v_perm_b32 v48, v46, v46, v1
    v_perm_b32 v49, v46, v46, v3
    v_perm_b32 v50, v46, v46, v5
    v_perm_b32 v51, v46, v46, v7
    v_perm_b32 v52, v46, v46, v2
    v_perm_b32 v53, v46, v46, v4
    v_perm_b32 v54, v46, v46, v6
    v_perm_b32 v55, v46, v46, v8
    v_perm_b32 v56, v47, v47, v1
    v_perm_b32 v57, v47, v47, v3
    v_perm_b32 v58, v47, v47, v5
    v_perm_b32 v59, v47, v47, v7
    v_perm_b32 v60, v47, v47, v2
    v_perm_b32 v61, v47, v47, v4
    v_perm_b32 v62, v47, v47, v6
    v_perm_b32 v63, v47, v47, v8
    s_waitcnt vmcnt(5)
    buffer_load_dwordx4 v[104:107], v26, s[40:43], s61 offen offset:2048 nt
    v_mfma_f32_16x16x32_bf16 v[28:31], v[48:51], v[80:83], v[28:31]
    s_waitcnt vmcnt(5)
    buffer_load_dwordx4 v[108:111], v26, s[40:43], s61 offen offset:3072 nt
    v_mfma_f32_16x16x32_bf16 v[28:31], v[52:55], v[84:87], v[28:31]
    s_addk_i32 s71, 7
    s_lshl_b32 s56, s71, 14
    s_xor_b32 s61, s56, s72
    s_waitcnt vmcnt(5)
    buffer_load_dwordx4 v[112:115], v26, s[40:43], s61 offen offset:0 nt
    v_mfma_f32_16x16x32_bf16 v[28:31], v[56:59], v[88:91], v[28:31]
    s_waitcnt vmcnt(5)
    buffer_load_dwordx4 v[116:119], v26, s[40:43], s61 offen offset:1024 nt
    v_mfma_f32_16x16x32_bf16 v[28:31], v[60:63], v[92:95], v[28:31]
    v_fma_f32 v42, v208, s60, -v41
    v_fma_f32 v43, v209, s60, -v41
    v_fma_f32 v44, v210, s60, -v41
    v_fma_f32 v45, v211, s60, -v41
    v_exp_f32 v42, v42
    v_exp_f32 v43, v43
    v_exp_f32 v44, v44
    v_exp_f32 v45, v45
    v_add_f32 v37, v37, v42
    v_cvt_pk_bf16_f32 v46, v42, v43
    v_cvt_pk_bf16_f32 v47, v44, v45
    v_add_f32 v43, v43, v44
    v_add_f32 v37, v37, v45
    v_add_f32 v37, v37, v43
    v_perm_b32 v48, v46, v46, v1
    v_perm_b32 v49, v46, v46, v3
    v_perm_b32 v50, v46, v46, v5
    v_perm_b32 v51, v46, v46, v7
    v_perm_b32 v52, v46, v46, v2
    v_perm_b32 v53, v46, v46, v4
    v_perm_b32 v54, v46, v46, v6
    v_perm_b32 v55, v46, v46, v8
    v_perm_b32 v56, v47, v47, v1
    v_perm_b32 v57, v47, v47, v3
    v_perm_b32 v58, v47, v47, v5
    v_perm_b32 v59, v47, v47, v7
    v_perm_b32 v60, v47, v47, v2
    v_perm_b32 v61, v47, v47, v4
    v_perm_b32 v62, v47, v47, v6
    v_perm_b32 v63, v47, v47, v8
    s_waitcnt vmcnt(5)
    buffer_load_dwordx4 v[120:123], v26, s[40:43], s61 offen offset:2048 nt
    v_mfma_f32_16x16x32_bf16 v[28:31], v[48:51], v[96:99], v[28:31]
    s_waitcnt vmcnt(5)
    buffer_load_dwordx4 v[124:127], v26, s[40:43], s61 offen offset:3072 nt
    v_mfma_f32_16x16x32_bf16 v[28:31], v[52:55], v[100:103], v[28:31]
    s_addk_i32 s71, 7
    s_lshl_b32 s56, s71, 14
    s_xor_b32 s61, s56, s72
    s_waitcnt vmcnt(5)
    buffer_load_dwordx4 v[128:131], v26, s[40:43], s61 offen offset:0 nt
    v_mfma_f32_16x16x32_bf16 v[28:31], v[56:59], v[104:107], v[28:31]
    s_waitcnt vmcnt(5)
    buffer_load_dwordx4 v[132:135], v26, s[40:43], s61 offen offset:1024 nt
    v_mfma_f32_16x16x32_bf16 v[28:31], v[60:63], v[108:111], v[28:31]
    v_fma_f32 v42, v212, s60, -v41
    v_fma_f32 v43, v213, s60, -v41
    v_fma_f32 v44, v214, s60, -v41
    v_fma_f32 v45, v215, s60, -v41
    v_exp_f32 v42, v42
    v_exp_f32 v43, v43
    v_exp_f32 v44, v44
    v_exp_f32 v45, v45
    v_add_f32 v37, v37, v42
    v_cvt_pk_bf16_f32 v46, v42, v43
    v_cvt_pk_bf16_f32 v47, v44, v45
    v_add_f32 v43, v43, v44
    v_add_f32 v37, v37, v45
    v_add_f32 v37, v37, v43
    v_perm_b32 v48, v46, v46, v1
    v_perm_b32 v49, v46, v46, v3
    v_perm_b32 v50, v46, v46, v5
    v_perm_b32 v51, v46, v46, v7
    v_perm_b32 v52, v46, v46, v2
    v_perm_b32 v53, v46, v46, v4
    v_perm_b32 v54, v46, v46, v6
    v_perm_b32 v55, v46, v46, v8
    v_perm_b32 v56, v47, v47, v1
    v_perm_b32 v57, v47, v47, v3
    v_perm_b32 v58, v47, v47, v5
    v_perm_b32 v59, v47, v47, v7
    v_perm_b32 v60, v47, v47, v2
    v_perm_b32 v61, v47, v47, v4
    v_perm_b32 v62, v47, v47, v6
    v_perm_b32 v63, v47, v47, v8
    s_waitcnt vmcnt(5)
    buffer_load_dwordx4 v[136:139], v26, s[40:43], s61 offen offset:2048 nt
    v_mfma_f32_16x16x32_bf16 v[28:31], v[48:51], v[112:115], v[28:31]
    s_waitcnt vmcnt(5)
    buffer_load_dwordx4 v[140:143], v26, s[40:43], s61 offen offset:3072 nt
    v_mfma_f32_16x16x32_bf16 v[28:31], v[52:55], v[116:119], v[28:31]
    s_addk_i32 s71, 7
    s_lshl_b32 s56, s71, 14
    s_xor_b32 s61, s56, s72
    s_waitcnt vmcnt(5)
    buffer_load_dwordx4 v[144:147], v26, s[40:43], s61 offen offset:0 nt
    v_mfma_f32_16x16x32_bf16 v[28:31], v[56:59], v[120:123], v[28:31]
    s_waitcnt vmcnt(5)
    buffer_load_dwordx4 v[148:151], v26, s[40:43], s61 offen offset:1024 nt
    v_mfma_f32_16x16x32_bf16 v[28:31], v[60:63], v[124:127], v[28:31]
    v_fma_f32 v42, v216, s60, -v41
    v_fma_f32 v43, v217, s60, -v41
    v_fma_f32 v44, v218, s60, -v41
    v_fma_f32 v45, v219, s60, -v41
    v_exp_f32 v42, v42
    v_exp_f32 v43, v43
    v_exp_f32 v44, v44
    v_exp_f32 v45, v45
    v_add_f32 v37, v37, v42
    v_cvt_pk_bf16_f32 v46, v42, v43
    v_cvt_pk_bf16_f32 v47, v44, v45
    v_add_f32 v43, v43, v44
    v_add_f32 v37, v37, v45
    v_add_f32 v37, v37, v43
    v_perm_b32 v48, v46, v46, v1
    v_perm_b32 v49, v46, v46, v3
    v_perm_b32 v50, v46, v46, v5
    v_perm_b32 v51, v46, v46, v7
    v_perm_b32 v52, v46, v46, v2
    v_perm_b32 v53, v46, v46, v4
    v_perm_b32 v54, v46, v46, v6
    v_perm_b32 v55, v46, v46, v8
    v_perm_b32 v56, v47, v47, v1
    v_perm_b32 v57, v47, v47, v3
    v_perm_b32 v58, v47, v47, v5
    v_perm_b32 v59, v47, v47, v7
    v_perm_b32 v60, v47, v47, v2
    v_perm_b32 v61, v47, v47, v4
    v_perm_b32 v62, v47, v47, v6
    v_perm_b32 v63, v47, v47, v8
    s_waitcnt vmcnt(5)
    buffer_load_dwordx4 v[152:155], v26, s[40:43], s61 offen offset:2048 nt
    v_mfma_f32_16x16x32_bf16 v[28:31], v[48:51], v[128:131], v[28:31]
    s_waitcnt vmcnt(5)
    buffer_load_dwordx4 v[156:159], v26, s[40:43], s61 offen offset:3072 nt
    v_mfma_f32_16x16x32_bf16 v[28:31], v[52:55], v[132:135], v[28:31]
    s_addk_i32 s71, 7
    s_lshl_b32 s56, s71, 14
    s_xor_b32 s61, s56, s72
    s_waitcnt vmcnt(5)
    buffer_load_dwordx4 v[160:163], v26, s[40:43], s61 offen offset:0 nt
    v_mfma_f32_16x16x32_bf16 v[28:31], v[56:59], v[136:139], v[28:31]
    s_waitcnt vmcnt(5)
    buffer_load_dwordx4 v[164:167], v26, s[40:43], s61 offen offset:1024 nt
    v_mfma_f32_16x16x32_bf16 v[28:31], v[60:63], v[140:143], v[28:31]
    v_fma_f32 v42, v220, s60, -v41
    v_fma_f32 v43, v221, s60, -v41
    v_fma_f32 v44, v222, s60, -v41
    v_fma_f32 v45, v223, s60, -v41
    v_exp_f32 v42, v42
    v_exp_f32 v43, v43
    v_exp_f32 v44, v44
    v_exp_f32 v45, v45
    v_add_f32 v37, v37, v42
    v_cvt_pk_bf16_f32 v46, v42, v43
    v_cvt_pk_bf16_f32 v47, v44, v45
    v_add_f32 v43, v43, v44
    v_add_f32 v37, v37, v45
    v_add_f32 v37, v37, v43
    v_perm_b32 v48, v46, v46, v1
    v_perm_b32 v49, v46, v46, v3
    v_perm_b32 v50, v46, v46, v5
    v_perm_b32 v51, v46, v46, v7
    v_perm_b32 v52, v46, v46, v2
    v_perm_b32 v53, v46, v46, v4
    v_perm_b32 v54, v46, v46, v6
    v_perm_b32 v55, v46, v46, v8
    v_perm_b32 v56, v47, v47, v1
    v_perm_b32 v57, v47, v47, v3
    v_perm_b32 v58, v47, v47, v5
    v_perm_b32 v59, v47, v47, v7
    v_perm_b32 v60, v47, v47, v2
    v_perm_b32 v61, v47, v47, v4
    v_perm_b32 v62, v47, v47, v6
    v_perm_b32 v63, v47, v47, v8
    s_waitcnt vmcnt(5)
    buffer_load_dwordx4 v[168:171], v26, s[40:43], s61 offen offset:2048 nt
    v_mfma_f32_16x16x32_bf16 v[28:31], v[48:51], v[144:147], v[28:31]
    s_waitcnt vmcnt(5)
    buffer_load_dwordx4 v[172:175], v26, s[40:43], s61 offen offset:3072 nt
    v_mfma_f32_16x16x32_bf16 v[28:31], v[52:55], v[148:151], v[28:31]
    s_addk_i32 s71, 7
    s_lshl_b32 s56, s71, 14
    s_xor_b32 s61, s56, s72
    s_waitcnt vmcnt(5)
    buffer_load_dwordx4 v[176:179], v26, s[40:43], s61 offen offset:0 nt
    v_mfma_f32_16x16x32_bf16 v[28:31], v[56:59], v[152:155], v[28:31]
    s_waitcnt vmcnt(5)
    buffer_load_dwordx4 v[180:183], v26, s[40:43], s61 offen offset:1024 nt
    v_mfma_f32_16x16x32_bf16 v[28:31], v[60:63], v[156:159], v[28:31]
    v_fma_f32 v42, v224, s60, -v41
    v_fma_f32 v43, v225, s60, -v41
    v_fma_f32 v44, v226, s60, -v41
    v_fma_f32 v45, v227, s60, -v41
    v_exp_f32 v42, v42
    v_exp_f32 v43, v43
    v_exp_f32 v44, v44
    v_exp_f32 v45, v45
    v_add_f32 v37, v37, v42
    v_cvt_pk_bf16_f32 v46, v42, v43
    v_cvt_pk_bf16_f32 v47, v44, v45
    v_add_f32 v43, v43, v44
    v_add_f32 v37, v37, v45
    v_add_f32 v37, v37, v43
    v_perm_b32 v48, v46, v46, v1
    v_perm_b32 v49, v46, v46, v3
    v_perm_b32 v50, v46, v46, v5
    v_perm_b32 v51, v46, v46, v7
    v_perm_b32 v52, v46, v46, v2
    v_perm_b32 v53, v46, v46, v4
    v_perm_b32 v54, v46, v46, v6
    v_perm_b32 v55, v46, v46, v8
    v_perm_b32 v56, v47, v47, v1
    v_perm_b32 v57, v47, v47, v3
    v_perm_b32 v58, v47, v47, v5
    v_perm_b32 v59, v47, v47, v7
    v_perm_b32 v60, v47, v47, v2
    v_perm_b32 v61, v47, v47, v4
    v_perm_b32 v62, v47, v47, v6
    v_perm_b32 v63, v47, v47, v8
    s_waitcnt vmcnt(5)
    buffer_load_dwordx4 v[184:187], v26, s[40:43], s61 offen offset:2048 nt
    v_mfma_f32_16x16x32_bf16 v[28:31], v[48:51], v[160:163], v[28:31]
    s_waitcnt vmcnt(5)
    buffer_load_dwordx4 v[188:191], v26, s[40:43], s61 offen offset:3072 nt
    v_mfma_f32_16x16x32_bf16 v[28:31], v[52:55], v[164:167], v[28:31]
    s_addk_i32 s71, 7
    s_lshl_b32 s56, s71, 14
    s_xor_b32 s61, s56, s72
    s_waitcnt vmcnt(5)
    buffer_load_dwordx4 v[64:67], v26, s[40:43], s61 offen offset:0 nt
    v_mfma_f32_16x16x32_bf16 v[28:31], v[56:59], v[168:171], v[28:31]
    s_waitcnt vmcnt(5)
    buffer_load_dwordx4 v[68:71], v26, s[40:43], s61 offen offset:1024 nt
    v_mfma_f32_16x16x32_bf16 v[28:31], v[60:63], v[172:175], v[28:31]
    v_fma_f32 v42, v228, s60, -v41
    v_fma_f32 v43, v229, s60, -v41
    v_fma_f32 v44, v230, s60, -v41
    v_fma_f32 v45, v231, s60, -v41
    v_exp_f32 v42, v42
    v_exp_f32 v43, v43
    v_exp_f32 v44, v44
    v_exp_f32 v45, v45
    v_add_f32 v37, v37, v42
    v_cvt_pk_bf16_f32 v46, v42, v43
    v_cvt_pk_bf16_f32 v47, v44, v45
    v_add_f32 v43, v43, v44
    v_add_f32 v37, v37, v45
    v_add_f32 v37, v37, v43
    v_perm_b32 v48, v46, v46, v1
    v_perm_b32 v49, v46, v46, v3
    v_perm_b32 v50, v46, v46, v5
    v_perm_b32 v51, v46, v46, v7
    v_perm_b32 v52, v46, v46, v2
    v_perm_b32 v53, v46, v46, v4
    v_perm_b32 v54, v46, v46, v6
    v_perm_b32 v55, v46, v46, v8
    v_perm_b32 v56, v47, v47, v1
    v_perm_b32 v57, v47, v47, v3
    v_perm_b32 v58, v47, v47, v5
    v_perm_b32 v59, v47, v47, v7
    v_perm_b32 v60, v47, v47, v2
    v_perm_b32 v61, v47, v47, v4
    v_perm_b32 v62, v47, v47, v6
    v_perm_b32 v63, v47, v47, v8
    s_waitcnt vmcnt(5)
    buffer_load_dwordx4 v[72:75], v26, s[40:43], s61 offen offset:2048 nt
    v_mfma_f32_16x16x32_bf16 v[28:31], v[48:51], v[176:179], v[28:31]
    s_waitcnt vmcnt(5)
    buffer_load_dwordx4 v[76:79], v26, s[40:43], s61 offen offset:3072 nt
    v_mfma_f32_16x16x32_bf16 v[28:31], v[52:55], v[180:183], v[28:31]
    s_addk_i32 s71, 7
    s_lshl_b32 s56, s71, 14
    s_xor_b32 s61, s56, s72
    s_waitcnt vmcnt(5)
    buffer_load_dwordx4 v[80:83], v26, s[40:43], s61 offen offset:0 nt
    v_mfma_f32_16x16x32_bf16 v[28:31], v[56:59], v[184:187], v[28:31]
    s_waitcnt vmcnt(5)
    buffer_load_dwordx4 v[84:87], v26, s[40:43], s61 offen offset:1024 nt
    v_mfma_f32_16x16x32_bf16 v[28:31], v[60:63], v[188:191], v[28:31]
    s_mov_b64 exec, 1
    ds_add_u32 v25, v20 offset:56
    s_mov_b64 exec, -1
    v_fma_f32 v42, v232, s60, -v41
    v_fma_f32 v43, v233, s60, -v41
    v_fma_f32 v44, v234, s60, -v41
    v_fma_f32 v45, v235, s60, -v41
    v_exp_f32 v42, v42
    v_exp_f32 v43, v43
    v_exp_f32 v44, v44
    v_exp_f32 v45, v45
    v_add_f32 v37, v37, v42
    v_cvt_pk_bf16_f32 v46, v42, v43
    v_cvt_pk_bf16_f32 v47, v44, v45
    v_add_f32 v43, v43, v44
    v_add_f32 v37, v37, v45
    v_add_f32 v37, v37, v43
    v_perm_b32 v48, v46, v46, v1
    v_perm_b32 v49, v46, v46, v3
    v_perm_b32 v50, v46, v46, v5
    v_perm_b32 v51, v46, v46, v7
    v_perm_b32 v52, v46, v46, v2
    v_perm_b32 v53, v46, v46, v4
    v_perm_b32 v54, v46, v46, v6
    v_perm_b32 v55, v46, v46, v8
    v_perm_b32 v56, v47, v47, v1
    v_perm_b32 v57, v47, v47, v3
    v_perm_b32 v58, v47, v47, v5
    v_perm_b32 v59, v47, v47, v7
    v_perm_b32 v60, v47, v47, v2
    v_perm_b32 v61, v47, v47, v4
    v_perm_b32 v62, v47, v47, v6
    v_perm_b32 v63, v47, v47, v8
    s_waitcnt vmcnt(5)
    buffer_load_dwordx4 v[88:91], v26, s[40:43], s61 offen offset:2048 nt
    v_mfma_f32_16x16x32_bf16 v[28:31], v[48:51], v[64:67], v[28:31]
    s_waitcnt vmcnt(5)
    buffer_load_dwordx4 v[92:95], v26, s[40:43], s61 offen offset:3072 nt
    v_mfma_f32_16x16x32_bf16 v[28:31], v[52:55], v[68:71], v[28:31]
    s_addk_i32 s71, 7
    s_lshl_b32 s56, s71, 14
    s_xor_b32 s61, s56, s72
    s_waitcnt vmcnt(5)
    buffer_load_dwordx4 v[96:99], v26, s[40:43], s61 offen offset:0 nt
    v_mfma_f32_16x16x32_bf16 v[28:31], v[56:59], v[72:75], v[28:31]
    s_waitcnt vmcnt(5)
    buffer_load_dwordx4 v[100:103], v26, s[40:43], s61 offen offset:1024 nt
    v_mfma_f32_16x16x32_bf16 v[28:31], v[60:63], v[76:79], v[28:31]
    v_fma_f32 v42, v236, s60, -v41
    v_fma_f32 v43, v237, s60, -v41
    v_fma_f32 v44, v238, s60, -v41
    v_fma_f32 v45, v239, s60, -v41
    v_exp_f32 v42, v42
    v_exp_f32 v43, v43
    v_exp_f32 v44, v44
    v_exp_f32 v45, v45
    v_add_f32 v37, v37, v42
    v_cvt_pk_bf16_f32 v46, v42, v43
    v_cvt_pk_bf16_f32 v47, v44, v45
    v_add_f32 v43, v43, v44
    v_add_f32 v37, v37, v45
    v_add_f32 v37, v37, v43
    v_perm_b32 v48, v46, v46, v1
    v_perm_b32 v49, v46, v46, v3
    v_perm_b32 v50, v46, v46, v5
    v_perm_b32 v51, v46, v46, v7
    v_perm_b32 v52, v46, v46, v2
    v_perm_b32 v53, v46, v46, v4
    v_perm_b32 v54, v46, v46, v6
    v_perm_b32 v55, v46, v46, v8
    v_perm_b32 v56, v47, v47, v1
    v_perm_b32 v57, v47, v47, v3
    v_perm_b32 v58, v47, v47, v5
    v_perm_b32 v59, v47, v47, v7
    v_perm_b32 v60, v47, v47, v2
    v_perm_b32 v61, v47, v47, v4
    v_perm_b32 v62, v47, v47, v6
    v_perm_b32 v63, v47, v47, v8
    s_waitcnt vmcnt(5)
    buffer_load_dwordx4 v[104:107], v26, s[40:43], s61 offen offset:2048 nt
    v_mfma_f32_16x16x32_bf16 v[28:31], v[48:51], v[80:83], v[28:31]
    s_waitcnt vmcnt(5)
    buffer_load_dwordx4 v[108:111], v26, s[40:43], s61 offen offset:3072 nt
    v_mfma_f32_16x16x32_bf16 v[28:31], v[52:55], v[84:87], v[28:31]
    s_addk_i32 s71, 7
    s_lshl_b32 s56, s71, 14
    s_xor_b32 s61, s56, s72
    s_waitcnt vmcnt(5)
    buffer_load_dwordx4 v[112:115], v26, s[40:43], s61 offen offset:0 nt
    v_mfma_f32_16x16x32_bf16 v[28:31], v[56:59], v[88:91], v[28:31]
    s_waitcnt vmcnt(5)
    buffer_load_dwordx4 v[116:119], v26, s[40:43], s61 offen offset:1024 nt
    v_mfma_f32_16x16x32_bf16 v[28:31], v[60:63], v[92:95], v[28:31]
    v_fma_f32 v42, v240, s60, -v41
    v_fma_f32 v43, v241, s60, -v41
    v_fma_f32 v44, v242, s60, -v41
    v_fma_f32 v45, v243, s60, -v41
    v_exp_f32 v42, v42
    v_exp_f32 v43, v43
    v_exp_f32 v44, v44
    v_exp_f32 v45, v45
    v_add_f32 v37, v37, v42
    v_cvt_pk_bf16_f32 v46, v42, v43
    v_cvt_pk_bf16_f32 v47, v44, v45
    v_add_f32 v43, v43, v44
    v_add_f32 v37, v37, v45
    v_add_f32 v37, v37, v43
    v_perm_b32 v48, v46, v46, v1
    v_perm_b32 v49, v46, v46, v3
    v_perm_b32 v50, v46, v46, v5
    v_perm_b32 v51, v46, v46, v7
    v_perm_b32 v52, v46, v46, v2
    v_perm_b32 v53, v46, v46, v4
    v_perm_b32 v54, v46, v46, v6
    v_perm_b32 v55, v46, v46, v8
    v_perm_b32 v56, v47, v47, v1
    v_perm_b32 v57, v47, v47, v3
    v_perm_b32 v58, v47, v47, v5
    v_perm_b32 v59, v47, v47, v7
    v_perm_b32 v60, v47, v47, v2
    v_perm_b32 v61, v47, v47, v4
    v_perm_b32 v62, v47, v47, v6
    v_perm_b32 v63, v47, v47, v8
    s_waitcnt vmcnt(5)
    buffer_load_dwordx4 v[120:123], v26, s[40:43], s61 offen offset:2048 nt
    v_mfma_f32_16x16x32_bf16 v[28:31], v[48:51], v[96:99], v[28:31]
    s_waitcnt vmcnt(5)
    buffer_load_dwordx4 v[124:127], v26, s[40:43], s61 offen offset:3072 nt
    v_mfma_f32_16x16x32_bf16 v[28:31], v[52:55], v[100:103], v[28:31]
    s_addk_i32 s71, 7
    s_lshl_b32 s56, s71, 14
    s_xor_b32 s61, s56, s72
    s_waitcnt vmcnt(5)
    buffer_load_dwordx4 v[128:131], v9, s[36:39], s61 offen offset:0 nt
    v_mfma_f32_16x16x32_bf16 v[28:31], v[56:59], v[104:107], v[28:31]
    s_waitcnt vmcnt(5)
    buffer_load_dwordx4 v[132:135], v9, s[36:39], s61 offen offset:1024 nt
    v_mfma_f32_16x16x32_bf16 v[28:31], v[60:63], v[108:111], v[28:31]
    v_fma_f32 v42, v244, s60, -v41
    v_fma_f32 v43, v245, s60, -v41
    v_fma_f32 v44, v246, s60, -v41
    v_fma_f32 v45, v247, s60, -v41
    v_exp_f32 v42, v42
    v_exp_f32 v43, v43
    v_exp_f32 v44, v44
    v_exp_f32 v45, v45
    v_add_f32 v37, v37, v42
    v_cvt_pk_bf16_f32 v46, v42, v43
    v_cvt_pk_bf16_f32 v47, v44, v45
    v_add_f32 v43, v43, v44
    v_add_f32 v37, v37, v45
    v_add_f32 v37, v37, v43
    v_perm_b32 v48, v46, v46, v1
    v_perm_b32 v49, v46, v46, v3
    v_perm_b32 v50, v46, v46, v5
    v_perm_b32 v51, v46, v46, v7
    v_perm_b32 v52, v46, v46, v2
    v_perm_b32 v53, v46, v46, v4
    v_perm_b32 v54, v46, v46, v6
    v_perm_b32 v55, v46, v46, v8
    v_perm_b32 v56, v47, v47, v1
    v_perm_b32 v57, v47, v47, v3
    v_perm_b32 v58, v47, v47, v5
    v_perm_b32 v59, v47, v47, v7
    v_perm_b32 v60, v47, v47, v2
    v_perm_b32 v61, v47, v47, v4
    v_perm_b32 v62, v47, v47, v6
    v_perm_b32 v63, v47, v47, v8
    s_waitcnt vmcnt(5)
    buffer_load_dwordx4 v[136:139], v9, s[36:39], s61 offen offset:2048 nt
    v_mfma_f32_16x16x32_bf16 v[28:31], v[48:51], v[112:115], v[28:31]
    s_waitcnt vmcnt(5)
    buffer_load_dwordx4 v[140:143], v9, s[36:39], s61 offen offset:3072 nt
    v_mfma_f32_16x16x32_bf16 v[28:31], v[52:55], v[116:119], v[28:31]
    s_waitcnt vmcnt(5)
    buffer_load_dwordx4 v[144:147], v26, s[40:43], s61 offen offset:0 nt
    v_mfma_f32_16x16x32_bf16 v[28:31], v[56:59], v[120:123], v[28:31]
    s_mov_b64 exec, 1
    ds_add_u32 v25, v20 offset:16
    s_mov_b64 exec, -1
    s_waitcnt vmcnt(5)
    buffer_load_dwordx4 v[148:151], v26, s[40:43], s61 offen offset:1024 nt
    v_mfma_f32_16x16x32_bf16 v[28:31], v[60:63], v[124:127], v[28:31]
L_loop:
    s_waitcnt vmcnt(5)
    buffer_load_dwordx4 v[152:155], v26, s[40:43], s61 offen offset:2048 nt
    s_waitcnt vmcnt(5)
    buffer_load_dwordx4 v[156:159], v26, s[40:43], s61 offen offset:3072 nt
    s_mov_b32 s63, 0
L_take2:
    ds_read_b32 v39, v19
    s_add_u32 s63, s63, 1
    s_waitcnt lgkmcnt(0)
    v_readfirstlane_b32 s71, v39
    s_cmp_lt_u32 s63, 2000000
    s_cselect_b32 s71, s71, -1
    s_cmp_eq_u32 s71, 0
    s_cbranch_scc1 L_take2
    s_cmp_lt_u32 s71, 128
    s_cbranch_scc0 L_last0
    v_add_u32 v19, 4, v19
    s_lshl_b32 s56, s71, 14
    s_xor_b32 s61, s56, s72
    s_waitcnt vmcnt(5)
    buffer_load_dwordx4 v[160:163], v9, s[36:39], s61 offen offset:0 nt
    s_waitcnt vmcnt(5)
    buffer_load_dwordx4 v[164:167], v9, s[36:39], s61 offen offset:1024 nt
    v_mfma_f32_16x16x32_bf16 v[48:51], v[128:131], v[12:15], 0
    v_mfma_f32_16x16x32_bf16 v[52:55], v[132:135], v[12:15], 0
    v_mfma_f32_16x16x32_bf16 v[56:59], v[136:139], v[12:15], 0
    v_mfma_f32_16x16x32_bf16 v[60:63], v[140:143], v[12:15], 0
    s_nop 4
    v_mov_b32_dpp v32, v48 quad_perm:[0,0,0,0] row_mask:0xf bank_mask:0xf
    v_mov_b32_dpp v33, v52 quad_perm:[0,0,0,0] row_mask:0xf bank_mask:0xf
    v_mov_b32_dpp v34, v56 quad_perm:[0,0,0,0] row_mask:0xf bank_mask:0xf
    v_mov_b32_dpp v35, v60 quad_perm:[0,0,0,0] row_mask:0xf bank_mask:0xf
    v_add_f32_dpp v32, v49, v32 quad_perm:[1,1,1,1] row_mask:0xf bank_mask:0xf
    v_add_f32_dpp v33, v53, v33 quad_perm:[1,1,1,1] row_mask:0xf bank_mask:0xf
    v_add_f32_dpp v34, v57, v34 quad_perm:[1,1,1,1] row_mask:0xf bank_mask:0xf
    v_add_f32_dpp v35, v61, v35 quad_perm:[1,1,1,1] row_mask:0xf bank_mask:0xf
    v_add_f32_dpp v32, v50, v32 quad_perm:[2,2,2,2] row_mask:0xf bank_mask:0xf
    v_add_f32_dpp v33, v54, v33 quad_perm:[2,2,2,2] row_mask:0xf bank_mask:0xf
    v_add_f32_dpp v34, v58, v34 quad_perm:[2,2,2,2] row_mask:0xf bank_mask:0xf
    v_add_f32_dpp v35, v62, v35 quad_perm:[2,2,2,2] row_mask:0xf bank_mask:0xf
    v_add_f32_dpp v32, v51, v32 quad_perm:[3,3,3,3] row_mask:0xf bank_mask:0xf
    v_add_f32_dpp v33, v55, v33 quad_perm:[3,3,3,3] row_mask:0xf bank_mask:0xf
    v_add_f32_dpp v34, v59, v34 quad_perm:[3,3,3,3] row_mask:0xf bank_mask:0xf
    v_add_f32_dpp v35, v63, v35 quad_perm:[3,3,3,3] row_mask:0xf bank_mask:0xf
    v_max3_f32 v38, v32, v33, v34
    v_max3_f32 v38, v38, v35, v36
    v_mov_b32 v39, v38
    s_nop 1
    v_permlane32_swap_b32 v38, v39
    v_max_f32 v38, v38, v39
    v_mov_b32 v39, v38
    s_nop 1
    v_permlane16_swap_b32 v38, v39
    v_max_f32 v38, v38, v39
    v_sub_f32 v40, v36, v38
    v_mul_f32 v41, s60, v38
    v_mul_f32 v40, s60, v40
    v_mov_b32 v36, v38
    v_exp_f32 v40, v40
    v_fma_f32 v42, v32, s60, -v41
    v_fma_f32 v43, v33, s60, -v41
    v_fma_f32 v44, v34, s60, -v41
    v_fma_f32 v45, v35, s60, -v41
    v_exp_f32 v42, v42
    v_exp_f32 v43, v43
    v_exp_f32 v44, v44
    v_exp_f32 v45, v45
    v_mul_f32 v28, v40, v28
    v_mul_f32 v29, v40, v29
    v_mul_f32 v30, v40, v30
    v_mul_f32 v31, v40, v31
    v_cvt_pk_bf16_f32 v46, v42, v43
    v_cvt_pk_bf16_f32 v47, v44, v45
    v_fma_f32 v37, v37, v40, v42
    v_add_f32 v43, v43, v44
    v_add_f32 v37, v37, v45
    v_add_f32 v37, v37, v43
    v_perm_b32 v48, v46, v46, v1
    v_perm_b32 v49, v46, v46, v3
    v_perm_b32 v50, v46, v46, v5
    v_perm_b32 v51, v46, v46, v7
    v_perm_b32 v52, v46, v46, v2
    v_perm_b32 v53, v46, v46, v4
    v_perm_b32 v54, v46, v46, v6
    v_perm_b32 v55, v46, v46, v8
    v_perm_b32 v56, v47, v47, v1
    v_perm_b32 v57, v47, v47, v3
    v_perm_b32 v58, v47, v47, v5
    v_perm_b32 v59, v47, v47, v7
    v_perm_b32 v60, v47, v47, v2
    v_perm_b32 v61, v47, v47, v4
    v_perm_b32 v62, v47, v47, v6
    v_perm_b32 v63, v47, v47, v8
    s_waitcnt vmcnt(5)
    buffer_load_dwordx4 v[168:171], v9, s[36:39], s61 offen offset:2048 nt
    v_mfma_f32_16x16x32_bf16 v[28:31], v[48:51], v[144:147], v[28:31]
    s_waitcnt vmcnt(5)
    buffer_load_dwordx4 v[172:175], v9, s[36:39], s61 offen offset:3072 nt
    v_mfma_f32_16x16x32_bf16 v[28:31], v[52:55], v[148:151], v[28:31]
    s_waitcnt vmcnt(5)
    buffer_load_dwordx4 v[176:179], v26, s[40:43], s61 offen offset:0 nt
    v_mfma_f32_16x16x32_bf16 v[28:31], v[56:59], v[152:155], v[28:31]
    s_mov_b64 exec, 1
    ds_add_u32 v25, v20 offset:16
    s_mov_b64 exec, -1
    s_waitcnt vmcnt(5)
    buffer_load_dwordx4 v[180:183], v26, s[40:43], s61 offen offset:1024 nt
    v_mfma_f32_16x16x32_bf16 v[28:31], v[60:63], v[156:159], v[28:31]
    s_waitcnt vmcnt(5)
    buffer_load_dwordx4 v[184:187], v26, s[40:43], s61 offen offset:2048 nt
    s_waitcnt vmcnt(5)
    buffer_load_dwordx4 v[188:191], v26, s[40:43], s61 offen offset:3072 nt
    s_mov_b32 s63, 0
L_take3:
    ds_read_b32 v39, v19
    s_add_u32 s63, s63, 1
    s_waitcnt lgkmcnt(0)
    v_readfirstlane_b32 s71, v39
    s_cmp_lt_u32 s63, 2000000
    s_cselect_b32 s71, s71, -1
    s_cmp_eq_u32 s71, 0
    s_cbranch_scc1 L_take3
    s_cmp_lt_u32 s71, 128
    s_cbranch_scc0 L_last1
    v_add_u32 v19, 4, v19
    s_lshl_b32 s56, s71, 14
    s_xor_b32 s61, s56, s72
    s_waitcnt vmcnt(5)
    buffer_load_dwordx4 v[128:131], v9, s[36:39], s61 offen offset:0 nt
    s_waitcnt vmcnt(5)
    buffer_load_dwordx4 v[132:135], v9, s[36:39], s61 offen offset:1024 nt
    v_mfma_f32_16x16x32_bf16 v[48:51], v[160:163], v[12:15], 0
    v_mfma_f32_16x16x32_bf16 v[52:55], v[164:167], v[12:15], 0
    v_mfma_f32_16x16x32_bf16 v[56:59], v[168:171], v[12:15], 0
    v_mfma_f32_16x16x32_bf16 v[60:63], v[172:175], v[12:15], 0
    s_nop 4
    v_mov_b32_dpp v32, v48 quad_perm:[0,0,0,0] row_mask:0xf bank_mask:0xf
    v_mov_b32_dpp v33, v52 quad_perm:[0,0,0,0] row_mask:0xf bank_mask:0xf
    v_mov_b32_dpp v34, v56 quad_perm:[0,0,0,0] row_mask:0xf bank_mask:0xf
    v_mov_b32_dpp v35, v60 quad_perm:[0,0,0,0] row_mask:0xf bank_mask:0xf
    v_add_f32_dpp v32, v49, v32 quad_perm:[1,1,1,1] row_mask:0xf bank_mask:0xf
    v_add_f32_dpp v33, v53, v33 quad_perm:[1,1,1,1] row_mask:0xf bank_mask:0xf
    v_add_f32_dpp v34, v57, v34 quad_perm:[1,1,1,1] row_mask:0xf bank_mask:0xf
    v_add_f32_dpp v35, v61, v35 quad_perm:[1,1,1,1] row_mask:0xf bank_mask:0xf
    v_add_f32_dpp v32, v50, v32 quad_perm:[2,2,2,2] row_mask:0xf bank_mask:0xf
    v_add_f32_dpp v33, v54, v33 quad_perm:[2,2,2,2] row_mask:0xf bank_mask:0xf
    v_add_f32_dpp v34, v58, v34 quad_perm:[2,2,2,2] row_mask:0xf bank_mask:0xf
    v_add_f32_dpp v35, v62, v35 quad_perm:[2,2,2,2] row_mask:0xf bank_mask:0xf
    v_add_f32_dpp v32, v51, v32 quad_perm:[3,3,3,3] row_mask:0xf bank_mask:0xf
    v_add_f32_dpp v33, v55, v33 quad_perm:[3,3,3,3] row_mask:0xf bank_mask:0xf
    v_add_f32_dpp v34, v59, v34 quad_perm:[3,3,3,3] row_mask:0xf bank_mask:0xf
    v_add_f32_dpp v35, v63, v35 quad_perm:[3,3,3,3] row_mask:0xf bank_mask:0xf
    v_max3_f32 v38, v32, v33, v34
    v_max3_f32 v38, v38, v35, v36
    v_mov_b32 v39, v38
    s_nop 1
    v_permlane32_swap_b32 v38, v39
    v_max_f32 v38, v38, v39
    v_mov_b32 v39, v38
    s_nop 1
    v_permlane16_swap_b32 v38, v39
    v_max_f32 v38, v38, v39
    v_sub_f32 v40, v36, v38
    v_mul_f32 v41, s60, v38
    v_mul_f32 v40, s60, v40
    v_mov_b32 v36, v38
    v_exp_f32 v40, v40
    v_fma_f32 v42, v32, s60, -v41
    v_fma_f32 v43, v33, s60, -v41
    v_fma_f32 v44, v34, s60, -v41
    v_fma_f32 v45, v35, s60, -v41
    v_exp_f32 v42, v42
    v_exp_f32 v43, v43
    v_exp_f32 v44, v44
    v_exp_f32 v45, v45
    v_mul_f32 v28, v40, v28
    v_mul_f32 v29, v40, v29
    v_mul_f32 v30, v40, v30
    v_mul_f32 v31, v40, v31
    v_cvt_pk_bf16_f32 v46, v42, v43
    v_cvt_pk_bf16_f32 v47, v44, v45
    v_fma_f32 v37, v37, v40, v42
    v_add_f32 v43, v43, v44
    v_add_f32 v37, v37, v45
    v_add_f32 v37, v37, v43
    v_perm_b32 v48, v46, v46, v1
    v_perm_b32 v49, v46, v46, v3
    v_perm_b32 v50, v46, v46, v5
    v_perm_b32 v51, v46, v46, v7
    v_perm_b32 v52, v46, v46, v2
    v_perm_b32 v53, v46, v46, v4
    v_perm_b32 v54, v46, v46, v6
    v_perm_b32 v55, v46, v46, v8
    v_perm_b32 v56, v47, v47, v1
    v_perm_b32 v57, v47, v47, v3
    v_perm_b32 v58, v47, v47, v5
    v_perm_b32 v59, v47, v47, v7
    v_perm_b32 v60, v47, v47, v2
    v_perm_b32 v61, v47, v47, v4
    v_perm_b32 v62, v47, v47, v6
    v_perm_b32 v63, v47, v47, v8
    s_waitcnt vmcnt(5)
    buffer_load_dwordx4 v[136:139], v9, s[36:39], s61 offen offset:2048 nt
    v_mfma_f32_16x16x32_bf16 v[28:31], v[48:51], v[176:179], v[28:31]
    s_waitcnt vmcnt(5)
    buffer_load_dwordx4 v[140:143], v9, s[36:39], s61 offen offset:3072 nt
    v_mfma_f32_16x16x32_bf16 v[28:31], v[52:55], v[180:183], v[28:31]
    s_waitcnt vmcnt(5)
    buffer_load_dwordx4 v[144:147], v26, s[40:43], s61 offen offset:0 nt
    v_mfma_f32_16x16x32_bf16 v[28:31], v[56:59], v[184:187], v[28:31]
    s_mov_b64 exec, 1
    ds_add_u32 v25, v20 offset:16
    s_mov_b64 exec, -1
    s_waitcnt vmcnt(5)
    buffer_load_dwordx4 v[148:151], v26, s[40:43], s61 offen offset:1024 nt
    v_mfma_f32_16x16x32_bf16 v[28:31], v[60:63], v[188:191], v[28:31]
    s_branch L_loop
L_none:
    s_mov_b64 exec, 1
    ds_add_u32 v25, v20 offset:4
    s_mov_b64 exec, -1
    v_mov_b32 v39, v37
    s_nop 1
    v_permlane32_swap_b32 v37, v39
    v_add_f32 v37, v37, v39
    v_mov_b32 v39, v37
    s_nop 1
    v_permlane16_swap_b32 v37, v39
    v_add_f32 v37, v37, v39
    ds_write_b64 v17, v[36:37]
    s_mov_b64 exec, 1
    ds_add_u32 v25, v20 offset:20
    s_mov_b64 exec, -1
    s_branch L_sdone
L_last0:
    s_mov_b64 exec, 1
    ds_add_u32 v25, v20 offset:4
    s_mov_b64 exec, -1
    s_waitcnt vmcnt(4)
    v_mfma_f32_16x16x32_bf16 v[48:51], v[128:131], v[12:15], 0
    v_mfma_f32_16x16x32_bf16 v[52:55], v[132:135], v[12:15], 0
    v_mfma_f32_16x16x32_bf16 v[56:59], v[136:139], v[12:15], 0
    v_mfma_f32_16x16x32_bf16 v[60:63], v[140:143], v[12:15], 0
    s_nop 4
    v_mov_b32_dpp v32, v48 quad_perm:[0,0,0,0] row_mask:0xf bank_mask:0xf
    v_mov_b32_dpp v33, v52 quad_perm:[0,0,0,0] row_mask:0xf bank_mask:0xf
    v_mov_b32_dpp v34, v56 quad_perm:[0,0,0,0] row_mask:0xf bank_mask:0xf
    v_mov_b32_dpp v35, v60 quad_perm:[0,0,0,0] row_mask:0xf bank_mask:0xf
    v_add_f32_dpp v32, v49, v32 quad_perm:[1,1,1,1] row_mask:0xf bank_mask:0xf
    v_add_f32_dpp v33, v53, v33 quad_perm:[1,1,1,1] row_mask:0xf bank_mask:0xf
    v_add_f32_dpp v34, v57, v34 quad_perm:[1,1,1,1] row_mask:0xf bank_mask:0xf
    v_add_f32_dpp v35, v61, v35 quad_perm:[1,1,1,1] row_mask:0xf bank_mask:0xf
    v_add_f32_dpp v32, v50, v32 quad_perm:[2,2,2,2] row_mask:0xf bank_mask:0xf
    v_add_f32_dpp v33, v54, v33 quad_perm:[2,2,2,2] row_mask:0xf bank_mask:0xf
    v_add_f32_dpp v34, v58, v34 quad_perm:[2,2,2,2] row_mask:0xf bank_mask:0xf
    v_add_f32_dpp v35, v62, v35 quad_perm:[2,2,2,2] row_mask:0xf bank_mask:0xf
    v_add_f32_dpp v32, v51, v32 quad_perm:[3,3,3,3] row_mask:0xf bank_mask:0xf
    v_add_f32_dpp v33, v55, v33 quad_perm:[3,3,3,3] row_mask:0xf bank_mask:0xf
    v_add_f32_dpp v34, v59, v34 quad_perm:[3,3,3,3] row_mask:0xf bank_mask:0xf
    v_add_f32_dpp v35, v63, v35 quad_perm:[3,3,3,3] row_mask:0xf bank_mask:0xf
    v_max3_f32 v38, v32, v33, v34
    v_max3_f32 v38, v38, v35, v36
    v_mov_b32 v39, v38
    s_nop 1
    v_permlane32_swap_b32 v38, v39
    v_max_f32 v38, v38, v39
    v_mov_b32 v39, v38
    s_nop 1
    v_permlane16_swap_b32 v38, v39
    v_max_f32 v38, v38, v39
    v_sub_f32 v40, v36, v38
    v_mul_f32 v41, s60, v38
    v_mul_f32 v40, s60, v40
    v_mov_b32 v36, v38
    v_exp_f32 v40, v40
    v_fma_f32 v42, v32, s60, -v41
    v_fma_f32 v43, v33, s60, -v41
    v_fma_f32 v44, v34, s60, -v41
    v_fma_f32 v45, v35, s60, -v41
    v_exp_f32 v42, v42
    v_exp_f32 v43, v43
    v_exp_f32 v44, v44
    v_exp_f32 v45, v45
    v_mul_f32 v28, v40, v28
    v_mul_f32 v29, v40, v29
    v_mul_f32 v30, v40, v30
    v_mul_f32 v31, v40, v31
    v_cvt_pk_bf16_f32 v46, v42, v43
    v_cvt_pk_bf16_f32 v47, v44, v45
    v_fma_f32 v37, v37, v40, v42
    v_add_f32 v43, v43, v44
    v_add_f32 v37, v37, v45
    v_add_f32 v37, v37, v43
    v_perm_b32 v48, v46, v46, v1
    v_perm_b32 v49, v46, v46, v3
    v_perm_b32 v50, v46, v46, v5
    v_perm_b32 v51, v46, v46, v7
    v_perm_b32 v52, v46, v46, v2
    v_perm_b32 v53, v46, v46, v4
    v_perm_b32 v54, v46, v46, v6
    v_perm_b32 v55, v46, v46, v8
    v_perm_b32 v56, v47, v47, v1
    v_perm_b32 v57, v47, v47, v3
    v_perm_b32 v58, v47, v47, v5
    v_perm_b32 v59, v47, v47, v7
    v_perm_b32 v60, v47, v47, v2
    v_perm_b32 v61, v47, v47, v4
    v_perm_b32 v62, v47, v47, v6
    v_perm_b32 v63, v47, v47, v8
    v_mov_b32 v39, v37
    s_nop 1
    v_permlane32_swap_b32 v37, v39
    v_add_f32 v37, v37, v39
    v_mov_b32 v39, v37
    s_nop 1
    v_permlane16_swap_b32 v37, v39
    v_add_f32 v37, v37, v39
    ds_write_b64 v17, v[36:37]
    s_mov_b64 exec, 1
    ds_add_u32 v25, v20 offset:20
    s_mov_b64 exec, -1
    s_waitcnt vmcnt(3)
    v_mfma_f32_16x16x32_bf16 v[28:31], v[48:51], v[144:147], v[28:31]
    s_waitcnt vmcnt(2)
    v_mfma_f32_16x16x32_bf16 v[28:31], v[52:55], v[148:151], v[28:31]
    s_waitcnt vmcnt(1)
    v_mfma_f32_16x16x32_bf16 v[28:31], v[56:59], v[152:155], v[28:31]
    s_waitcnt vmcnt(0)
    v_mfma_f32_16x16x32_bf16 v[28:31], v[60:63], v[156:159], v[28:31]
    s_branch L_sdone
L_last1:
    s_mov_b64 exec, 1
    ds_add_u32 v25, v20 offset:4
    s_mov_b64 exec, -1
    s_waitcnt vmcnt(4)
    v_mfma_f32_16x16x32_bf16 v[48:51], v[160:163], v[12:15], 0
    v_mfma_f32_16x16x32_bf16 v[52:55], v[164:167], v[12:15], 0
    v_mfma_f32_16x16x32_bf16 v[56:59], v[168:171], v[12:15], 0
    v_mfma_f32_16x16x32_bf16 v[60:63], v[172:175], v[12:15], 0
    s_nop 4
    v_mov_b32_dpp v32, v48 quad_perm:[0,0,0,0] row_mask:0xf bank_mask:0xf
    v_mov_b32_dpp v33, v52 quad_perm:[0,0,0,0] row_mask:0xf bank_mask:0xf
    v_mov_b32_dpp v34, v56 quad_perm:[0,0,0,0] row_mask:0xf bank_mask:0xf
    v_mov_b32_dpp v35, v60 quad_perm:[0,0,0,0] row_mask:0xf bank_mask:0xf
    v_add_f32_dpp v32, v49, v32 quad_perm:[1,1,1,1] row_mask:0xf bank_mask:0xf
    v_add_f32_dpp v33, v53, v33 quad_perm:[1,1,1,1] row_mask:0xf bank_mask:0xf
    v_add_f32_dpp v34, v57, v34 quad_perm:[1,1,1,1] row_mask:0xf bank_mask:0xf
    v_add_f32_dpp v35, v61, v35 quad_perm:[1,1,1,1] row_mask:0xf bank_mask:0xf
    v_add_f32_dpp v32, v50, v32 quad_perm:[2,2,2,2] row_mask:0xf bank_mask:0xf
    v_add_f32_dpp v33, v54, v33 quad_perm:[2,2,2,2] row_mask:0xf bank_mask:0xf
    v_add_f32_dpp v34, v58, v34 quad_perm:[2,2,2,2] row_mask:0xf bank_mask:0xf
    v_add_f32_dpp v35, v62, v35 quad_perm:[2,2,2,2] row_mask:0xf bank_mask:0xf
    v_add_f32_dpp v32, v51, v32 quad_perm:[3,3,3,3] row_mask:0xf bank_mask:0xf
    v_add_f32_dpp v33, v55, v33 quad_perm:[3,3,3,3] row_mask:0xf bank_mask:0xf
    v_add_f32_dpp v34, v59, v34 quad_perm:[3,3,3,3] row_mask:0xf bank_mask:0xf
    v_add_f32_dpp v35, v63, v35 quad_perm:[3,3,3,3] row_mask:0xf bank_mask:0xf
    v_max3_f32 v38, v32, v33, v34
    v_max3_f32 v38, v38, v35, v36
    v_mov_b32 v39, v38
    s_nop 1
    v_permlane32_swap_b32 v38, v39
    v_max_f32 v38, v38, v39
    v_mov_b32 v39, v38
    s_nop 1
    v_permlane16_swap_b32 v38, v39
    v_max_f32 v38, v38, v39
    v_sub_f32 v40, v36, v38
    v_mul_f32 v41, s60, v38
    v_mul_f32 v40, s60, v40
    v_mov_b32 v36, v38
    v_exp_f32 v40, v40
    v_fma_f32 v42, v32, s60, -v41
    v_fma_f32 v43, v33, s60, -v41
    v_fma_f32 v44, v34, s60, -v41
    v_fma_f32 v45, v35, s60, -v41
    v_exp_f32 v42, v42
    v_exp_f32 v43, v43
    v_exp_f32 v44, v44
    v_exp_f32 v45, v45
    v_mul_f32 v28, v40, v28
    v_mul_f32 v29, v40, v29
    v_mul_f32 v30, v40, v30
    v_mul_f32 v31, v40, v31
    v_cvt_pk_bf16_f32 v46, v42, v43
    v_cvt_pk_bf16_f32 v47, v44, v45
    v_fma_f32 v37, v37, v40, v42
    v_add_f32 v43, v43, v44
    v_add_f32 v37, v37, v45
    v_add_f32 v37, v37, v43
    v_perm_b32 v48, v46, v46, v1
    v_perm_b32 v49, v46, v46, v3
    v_perm_b32 v50, v46, v46, v5
    v_perm_b32 v51, v46, v46, v7
    v_perm_b32 v52, v46, v46, v2
    v_perm_b32 v53, v46, v46, v4
    v_perm_b32 v54, v46, v46, v6
    v_perm_b32 v55, v46, v46, v8
    v_perm_b32 v56, v47, v47, v1
    v_perm_b32 v57, v47, v47, v3
    v_perm_b32 v58, v47, v47, v5
    v_perm_b32 v59, v47, v47, v7
    v_perm_b32 v60, v47, v47, v2
    v_perm_b32 v61, v47, v47, v4
    v_perm_b32 v62, v47, v47, v6
    v_perm_b32 v63, v47, v47, v8
    v_mov_b32 v39, v37
    s_nop 1
    v_permlane32_swap_b32 v37, v39
    v_add_f32 v37, v37, v39
    v_mov_b32 v39, v37
    s_nop 1
    v_permlane16_swap_b32 v37, v39
    v_add_f32 v37, v37, v39
    ds_write_b64 v17, v[36:37]
    s_mov_b64 exec, 1
    ds_add_u32 v25, v20 offset:20
    s_mov_b64 exec, -1
    s_waitcnt vmcnt(3)
    v_mfma_f32_16x16x32_bf16 v[28:31], v[48:51], v[176:179], v[28:31]
    s_waitcnt vmcnt(2)
    v_mfma_f32_16x16x32_bf16 v[28:31], v[52:55], v[180:183], v[28:31]
    s_waitcnt vmcnt(1)
    v_mfma_f32_16x16x32_bf16 v[28:31], v[56:59], v[184:187], v[28:31]
    s_waitcnt vmcnt(0)
    v_mfma_f32_16x16x32_bf16 v[28:31], v[60:63], v[188:191], v[28:31]
L_sdone:
    s_mov_b32 exec_hi, 0
    s_nop 6
    ds_write_b128 v16, v[28:31]
    s_mov_b64 exec, 1
    ds_add_u32 v25, v20 offset:8
    s_mov_b64 exec, -1
    s_bitcmp1_b32 s71, 2
    s_cbranch_scc1 L_fin
    s_setprio 0
    s_mov_b32 s44, s30
    s_mov_b32 s45, s31
    s_mov_b32 s46, 0x200000
    s_mov_b32 s47, 0x20000
    ds_read_b32 v35, v25 offset:60
    s_mov_b32 s8, 0x07060501
    s_mov_b32 s9, 0x07060502
    s_mov_b32 s10, 0x07060503
    s_mov_b32 s11, 0x0c04000c
    v_lshrrev_b32 v12, 4, v0
    v_bfe_u32 v13, v0, 2, 2
    v_lshlrev_b32 v14, 11, v12
    v_lshl_add_u32 v14, v13, 8, v14
    v_and_b32 v15, 1, v0
    v_lshl_add_u32 v14, v15, 3, v14
    v_bfe_u32 v18, v0, 1, 1
    s_lshl_b32 s56, s3, 2
    v_add_u32 v21, s56, v18
    v_lshlrev_b32 v13, 1, v13
    v_xor_b32 v21, v21, v13
    v_and_b32 v13, 1, v12
    v_lshlrev_b32 v13, 3, v13
    v_xor_b32 v21, v21, v13
    v_lshl_add_u32 v22, v21, 4, v14
    v_xor_b32 v23, 32, v22
    v_lshlrev_b32 v16, 4, v12
    v_lshl_add_u32 v17, v15, 13, v16
    v_lshl_add_u32 v17, v18, 6, v17
    v_add_u32 v16, 135680, v16
    v_cmp_ne_u32 s[66:67], 0, v18
    s_and_b32 s29, s71, 3
    s_lshl_b32 s29, s29, 1
    s_lshr_b32 s56, s3, 1
    s_add_u32 s29, s29, s56
    s_mov_b32 s48, s26
    s_mov_b32 s49, s27
    s_mov_b32 s50, 0x800
    s_mov_b32 s51, 0x20000
    s_mov_b32 s28, 0
    s_lshl_b32 s62, s29, 14
    s_add_u32 s62, s62, 786432
    s_lshl_b32 s61, s32, 8
    s_add_u32 s61, s61, s62
    s_lshl_b32 s58, s32, 3
    s_add_u32 s62, s62, s58
    v_lshrrev_b32 v53, 5, v0
    v_lshrrev_b32 v36, 3, v0
    v_lshlrev_b32 v36, 8, v36
    v_and_b32 v54, 7, v0
    v_lshl_add_u32 v36, v54, 4, v36
    v_lshlrev_b32 v54, 3, v54
    v_lshl_add_u32 v54, v53, 2, v54
    s_lshl_b32 s59, s29, 7
    s_lshl_b32 s58, s32, 2
    s_add_u32 s59, s59, s58
    s_addk_i32 s59, 1024
    ds_read_b32 v24, v25 offset:12
    s_waitcnt lgkmcnt(0)
    v_readfirstlane_b32 s56, v24
    s_nop 0
    s_add_u32 s62, s62, s56
    v_readfirstlane_b32 s34, v35
    s_and_b32 s56, s3, 1
    s_lshl_b32 s56, s56, 7
    s_add_u32 s61, s61, s56
    s_and_b32 s57, s32, 15
    s_or_b32 s57, s57, s56
    s_mov_b32 s63, 0
L_flag4:
    ds_read_b32 v24, v25 offset:52
    s_add_u32 s63, s63, 1
    s_waitcnt lgkmcnt(0)
    v_cmp_gt_u32 vcc, 2, v24
    s_cbranch_vccz L_flag4_ok
    s_sleep 1
    s_cmp_lt_u32 s63, 2000000
    s_cbranch_scc1 L_flag4
L_flag4_ok:
    ds_read_b64_tr_b16 v[64:65], v22 offset:0
    ds_read_b64_tr_b16 v[66:67], v22 offset:1024
    ds_read_b64_tr_b16 v[68:69], v22 offset:8192
    ds_read_b64_tr_b16 v[70:71], v22 offset:9216
    ds_read_b64_tr_b16 v[72:73], v22 offset:16384
    ds_read_b64_tr_b16 v[74:75], v22 offset:17408
    ds_read_b64_tr_b16 v[76:77], v22 offset:24576
    ds_read_b64_tr_b16 v[78:79], v22 offset:25600
    ds_read_b64_tr_b16 v[80:81], v23 offset:0
    ds_read_b64_tr_b16 v[82:83], v23 offset:1024
    ds_read_b64_tr_b16 v[84:85], v23 offset:8192
    ds_read_b64_tr_b16 v[86:87], v23 offset:9216
    ds_read_b64_tr_b16 v[88:89], v23 offset:16384
    ds_read_b64_tr_b16 v[90:91], v23 offset:17408
    ds_read_b64_tr_b16 v[92:93], v23 offset:24576
    ds_read_b64_tr_b16 v[94:95], v23 offset:25600
    s_mov_b32 s63, 0
L_yo:
    ds_read_b32 v38, v25 offset:36
    ds_read_b128 v[96:99], v16 offset:0
    ds_read_b128 v[100:103], v16 offset:64
    ds_read_b128 v[104:107], v16 offset:128
    ds_read_b128 v[108:111], v16 offset:192
    s_add_u32 s63, s63, 1
    s_waitcnt lgkmcnt(0)
    v_cmp_eq_u32 vcc, 0, v38
    s_cbranch_vccz L_yo_ok
    s_cmp_lt_u32 s63, 2000000
    s_cbranch_scc1 L_yo
L_yo_ok:
    v_mfma_f32_16x16x32_bf16 v[112:115], v[64:67], v[96:99], 0
    v_mfma_f32_16x16x32_bf16 v[116:119], v[80:83], v[96:99], 0
    v_mfma_f32_16x16x32_bf16 v[112:115], v[68:71], v[100:103], v[112:115]
    v_mfma_f32_16x16x32_bf16 v[116:119], v[84:87], v[100:103], v[116:119]
    v_mfma_f32_16x16x32_bf16 v[112:115], v[72:75], v[104:107], v[112:115]
    v_mfma_f32_16x16x32_bf16 v[116:119], v[88:91], v[104:107], v[116:119]
    v_mfma_f32_16x16x32_bf16 v[112:115], v[76:79], v[108:111], v[112:115]
    v_mfma_f32_16x16x32_bf16 v[116:119], v[92:95], v[108:111], v[116:119]
    s_mov_b32 exec_lo, 0x000f000f
    s_mov_b32 exec_hi, 0x000f000f
    s_nop 5
    v_cndmask_b32 v28, v112, v116, s[66:67]
    v_cndmask_b32 v29, v113, v117, s[66:67]
    v_cndmask_b32 v30, v114, v118, s[66:67]
    v_cndmask_b32 v31, v115, v119, s[66:67]
    v_pk_mul_f32 v[28:29], v[28:29], v[38:39] op_sel_hi:[1,0]
    v_pk_mul_f32 v[30:31], v[30:31], v[38:39] op_sel_hi:[1,0]
    v_perm_b32 v32, v28, v31, s8
    v_perm_b32 v33, v29, v31, s9
    v_perm_b32 v34, v30, v31, s10
    buffer_store_dwordx4 v[32:35], v17, s[44:47], s61 offen sc1
    s_mov_b64 exec, -1
    s_cmp_eq_u32 s57, 0
    s_cbranch_scc1 L_wt_sum
    s_branch L_fin
L_w67:
    s_cmp_eq_u32 s3, 7
    s_cbranch_scc1 L_w7
    v_mov_b32 v28, 0
    v_mov_b32 v29, 0
    v_mov_b32 v30, 0
    v_mov_b32 v31, 0
    v_add_u32 v24, v26, v25
    ds_write_b128 v24, v[28:31]
    s_cmp_lt_u32 s33, 4
    s_cselect_b32 s28, 0, 0
    s_cmp_eq_u32 s33, 7
    s_cselect_b32 s28, 0, s28
    s_add_u32 s56, s33, 105
    v_mad_u32_u24 v28, v0, 7, s56
    s_add_u32 s56, s33, 101
    v_mad_u32_u24 v29, v0, 3, s56
    v_cmp_gt_u32 vcc, 0, v0
    s_nop 1
    v_cndmask_b32 v28, v29, v28, vcc
    v_cmp_gt_u32 vcc, s28, v0
    s_nop 1
    v_cndmask_b32 v28, v30, v28, vcc
    v_lshl_add_u32 v24, v0, 2, v25
    ds_write_b32 v24, v28 offset:64
    s_cmp_eq_u32 s33, 7
    s_cbranch_scc1 L_acu
    s_waitcnt lgkmcnt(0)
    s_barrier
    s_mov_b32 s44, s30
    s_mov_b32 s45, s31
    s_mov_b32 s46, 0x200000
    s_mov_b32 s47, 0x20000
L_s2:
    s_setprio 3
    s_load_dword s34, s[30:31], 0
    v_and_b32 v24, 1, v0
    v_cmp_eq_u32 vcc, 1, v24
    v_mov_b32 v28, 0xc0c0100
    v_mov_b32 v1, 0x1000c0c
    v_cndmask_b32 v28, v28, v1, vcc
    v_mov_b32 v29, 0xc0c0302
    v_mov_b32 v1, 0x3020c0c
    v_cndmask_b32 v29, v29, v1, vcc
    v_bfe_u32 v24, v0, 1, 2
    v_cmp_eq_u32 vcc, 0, v24
    v_mov_b32 v1, 0x0c0c0c0c
    v_mov_b32 v2, 0x0c0c0c0c
    v_cndmask_b32 v1, v1, v28, vcc
    v_cndmask_b32 v2, v2, v29, vcc
    v_cmp_eq_u32 vcc, 1, v24
    v_mov_b32 v3, 0x0c0c0c0c
    v_mov_b32 v4, 0x0c0c0c0c
    v_cndmask_b32 v3, v3, v28, vcc
    v_cndmask_b32 v4, v4, v29, vcc
    v_cmp_eq_u32 vcc, 2, v24
    v_mov_b32 v5, 0x0c0c0c0c
    v_mov_b32 v6, 0x0c0c0c0c
    v_cndmask_b32 v5, v5, v28, vcc
    v_cndmask_b32 v6, v6, v29, vcc
    v_cmp_eq_u32 vcc, 3, v24
    v_mov_b32 v7, 0x0c0c0c0c
    v_mov_b32 v8, 0x0c0c0c0c
    v_cndmask_b32 v7, v7, v28, vcc
    v_cndmask_b32 v8, v8, v29, vcc
    v_lshlrev_b32 v27, 4, v11
    v_bfe_u32 v24, v0, 4, 1
    v_lshl_add_u32 v27, v24, 3, v27
    v_lshrrev_b32 v24, 5, v0
    v_lshl_add_u32 v27, v24, 2, v27
    s_mov_b32 s8, 0x07060501
    s_mov_b32 s9, 0x07060502
    s_mov_b32 s10, 0x07060503
    s_mov_b32 s11, 0x0c04000c
    s_lshl_b32 s57, s32, 11
    s_add_u32 s57, s57, 131072
    s_waitcnt lgkmcnt(0)
    s_add_u32 s34, s34, 0x9e3779b9
    v_mov_b32 v35, s34
    ds_write_b32 v25, v35 offset:60
    s_add_u32 s64, s30, s57
    s_addc_u32 s65, s31, 0
    s_mov_b32 s63, 0
L_pre22:
    s_load_dword s68, s[64:65], 508 glc
    s_load_dword s69, s[64:65], 1020 glc
    s_load_dword s70, s[64:65], 1532 glc
    s_load_dword s71, s[64:65], 2044 glc
    s_mov_b32 s58, 0
    s_add_u32 s63, s63, 1
    s_waitcnt lgkmcnt(0)
    s_cmp_lg_u32 s68, s34
    s_addc_u32 s58, s58, 0
    s_cmp_lg_u32 s69, s34
    s_addc_u32 s58, s58, 0
    s_cmp_lg_u32 s70, s34
    s_addc_u32 s58, s58, 0
    s_cmp_lg_u32 s71, s34
    s_addc_u32 s58, s58, 0
    s_cmp_le_u32 s58, 0
    s_cbranch_scc1 L_pre22_ok
    s_sleep 2
    s_cmp_lt_u32 s63, 200000
    s_cbranch_scc1 L_pre22
L_pre22_ok:
    s_mov_b32 s63, 0
    buffer_load_dwordx4 v[56:59], v26, s[44:47], s57 offen offset:0 sc1
    buffer_load_dwordx4 v[60:63], v26, s[44:47], s57 offen offset:1024 sc1
L_poll23:
    s_waitcnt vmcnt(0)
    v_cmp_ne_u32 s[68:69], s34, v59
    v_cmp_ne_u32 s[70:71], s34, v63
    s_nop 0
    s_or_b64 vcc, s[68:69], s[70:71]
    s_cbranch_scc0 L_poll23_ok
    s_mov_b64 exec, s[68:69]
    buffer_load_dwordx4 v[56:59], v26, s[44:47], s57 offen offset:0 sc1
    s_mov_b64 exec, s[70:71]
    buffer_load_dwordx4 v[60:63], v26, s[44:47], s57 offen offset:1024 sc1
    s_mov_b64 exec, -1
    s_add_u32 s63, s63, 1
    s_cmp_lt_u32 s63, 200000
    s_cbranch_scc1 L_poll23
    s_waitcnt vmcnt(0)
L_poll23_ok:
    v_perm_b32 v59, v57, v56, s11
    v_perm_b32 v63, v61, v60, s11
    v_lshl_or_b32 v59, v58, 24, v59
    v_lshl_or_b32 v63, v62, 24, v63
    v_add_f32 v56, v56, v60
    v_add_f32 v57, v57, v61
    v_add_f32 v58, v58, v62
    v_add_f32 v59, v59, v63
    v_add_u32 v15, 135168, v27
    v_permlane32_swap_b32 v56, v58
    v_permlane32_swap_b32 v57, v59
    v_add_f32 v32, v56, v58
    v_add_f32 v33, v57, v59
    v_cvt_pk_bf16_f32 v24, v32, v33
    ds_write_b32 v15, v24
    v_mov_b32 v24, 1
    s_mov_b64 exec, 1
    ds_add_u32 v25, v24 offset:0
    s_mov_b64 exec, -1
    v_lshrrev_b32 v53, 5, v0
    v_and_b32 v52, 31, v0
    v_lshlrev_b32 v52, 4, v52
    v_add_u32 v30, 140288, v52
    v_mov_b32 v31, 139520
    v_lshl_add_u32 v52, v53, 13, v52
    v_add_u32 v15, 135680, v27
    v_mov_b32 v35, s34
    v_and_b32 v24, 16, v0
    v_cmp_ne_u32 vcc, 0, v24
    v_cmp_gt_u32 s[66:67], 32, v0
    s_nop 0
    v_cndmask_b32 v60, v1, v5, vcc
    v_cndmask_b32 v61, v2, v6, vcc
    v_cndmask_b32 v62, v3, v7, vcc
    v_cndmask_b32 v63, v4, v8, vcc
    s_lshr_b32 s57, s32, 1
    s_lshl_b32 s57, s57, 14
    s_and_b32 s56, s32, 1
    s_lshl_b32 s56, s56, 12
    s_add_u32 s57, s57, s56
    s_add_u32 s57, s57, 524288
    s_lshl_b32 s35, s33, 9
    s_add_u32 s35, s35, s57
    s_cmp_eq_u32 s33, 0
    s_cselect_b32 s68, 0, -1
    s_cmp_eq_u32 s33, 1
    s_cselect_b32 s69, 0, -1
    s_cmp_eq_u32 s33, 2
    s_cselect_b32 s70, 0, -1
    s_cmp_eq_u32 s33, 3
    s_cselect_b32 s71, 0, -1
    s_cmp_eq_u32 s33, 4
    s_cselect_b32 s72, 0, -1
    s_cmp_eq_u32 s33, 5
    s_cselect_b32 s73, 0, -1
    s_cmp_eq_u32 s33, 6
    s_cselect_b32 s74, 0, -1
    s_cmp_eq_u32 s33, 7
    s_cselect_b32 s75, 0, -1
    s_lshl_b32 s56, s32, 10
    s_add_u32 s56, s56, 32768
    s_add_u32 s64, s30, s56
    s_addc_u32 s65, s31, 0
    s_lshl_b32 s58, s28, 2
    v_add_u32 v28, s58, v25
    s_add_u32 s58, s58, 4
    s_mov_b32 s63, 0
    s_mov_b32 s80, 0
L_disp:
    ds_read_b32 v24, v25 offset:16
    s_add_u32 s63, s63, 1
    s_waitcnt lgkmcnt(0)
    v_readfirstlane_b32 s56, v24
    s_nop 0
    s_cmp_ge_u32 s56, s58
    s_cbranch_scc1 L_disp_go
    s_sleep 1
    s_cmp_lt_u32 s63, 2000000
    s_cbranch_scc1 L_disp
L_disp_go:
    s_mov_b32 s80, 1
    s_atomic_add s80, s[64:65], 0 glc
    s_add_u32 s58, s58, 4
    s_waitcnt lgkmcnt(0)
    v_mov_b32 v24, s80
    ds_write_b32 v28, v24 offset:64
    v_add_u32 v28, 4, v28
    s_cmp_lt_u32 s80, 128
    s_cbranch_scc1 L_disp
    ds_write_b32 v25, v24 offset:32
    ds_read_b32 v24, v25 offset:12
    s_waitcnt lgkmcnt(0)
    v_readfirstlane_b32 s56, v24
    s_nop 0
    s_add_u32 s57, s57, s56
    s_mov_b32 s63, 0
L_flag24:
    ds_read_b32 v24, v25 offset:20
    s_add_u32 s63, s63, 1
    s_waitcnt lgkmcnt(0)
    v_cmp_gt_u32 vcc, 4, v24
    s_cbranch_vccz L_flag24_ok
    s_sleep 1
    s_cmp_lt_u32 s63, 2000000
    s_cbranch_scc1 L_flag24
L_flag24_ok:
    ds_read_b128 v[40:43], v31
    ds_read_b128 v[44:47], v31 offset:16
    s_waitcnt lgkmcnt(0)
    v_max3_f32 v28, v40, v42, v44
    v_max_f32 v28, v28, v46
    v_sub_f32 v40, v40, v28
    v_sub_f32 v42, v42, v28
    v_sub_f32 v44, v44, v28
    v_sub_f32 v46, v46, v28
    v_mul_f32 v40, s60, v40
    v_mul_f32 v42, s60, v42
    v_mul_f32 v44, s60, v44
    v_mul_f32 v46, s60, v46
    v_exp_f32 v40, v40
    v_exp_f32 v42, v42
    v_exp_f32 v44, v44
    v_exp_f32 v46, v46
    v_mul_f32 v29, v40, v41
    v_fmac_f32 v29, v42, v43
    v_fmac_f32 v29, v44, v45
    v_fmac_f32 v29, v46, v47
    v_max_f32 v24, 0x00800000, v29
    v_rcp_f32 v24, v24
    v_log_f32 v29, v29
    v_mul_f32 v40, v24, v40
    v_mul_f32 v42, v24, v42
    v_mul_f32 v44, v24, v44
    v_mul_f32 v46, v24, v46
    v_fma_f32 v34, v28, s60, v29
    s_mov_b32 s63, 0
L_flag25:
    ds_read_b32 v24, v25 offset:8
    s_add_u32 s63, s63, 1
    s_waitcnt lgkmcnt(0)
    v_cmp_gt_u32 vcc, 4, v24
    s_cbranch_vccz L_flag25_ok
    s_cmp_lt_u32 s63, 2000000
    s_cbranch_scc1 L_flag25
L_flag25_ok:
    ds_read_b128 v[80:83], v30 offset:0
    ds_read_b128 v[84:87], v30 offset:512
    ds_read_b128 v[88:91], v30 offset:1024
    ds_read_b128 v[92:95], v30 offset:1536
    s_waitcnt lgkmcnt(3)
    v_pk_mul_f32 v[48:49], v[80:81], v[40:41] op_sel_hi:[1,0]
    v_pk_mul_f32 v[50:51], v[82:83], v[40:41] op_sel_hi:[1,0]
    s_waitcnt lgkmcnt(2)
    v_pk_fma_f32 v[48:49], v[84:85], v[42:43], v[48:49] op_sel_hi:[1,0,1]
    v_pk_fma_f32 v[50:51], v[86:87], v[42:43], v[50:51] op_sel_hi:[1,0,1]
    s_waitcnt lgkmcnt(1)
    v_pk_fma_f32 v[48:49], v[88:89], v[44:45], v[48:49] op_sel_hi:[1,0,1]
    v_pk_fma_f32 v[50:51], v[90:91], v[44:45], v[50:51] op_sel_hi:[1,0,1]
    s_waitcnt lgkmcnt(0)
    v_pk_fma_f32 v[48:49], v[92:93], v[46:47], v[48:49] op_sel_hi:[1,0,1]
    v_pk_fma_f32 v[50:51], v[94:95], v[46:47], v[50:51] op_sel_hi:[1,0,1]
    v_cvt_pk_bf16_f32 v32, v48, v49
    v_cvt_pk_bf16_f32 v33, v50, v51
    buffer_store_dwordx4 v[32:35], v52, s[44:47], s35 offen sc1
    v_mov_b32 v24, 1
    s_mov_b64 exec, 1
    ds_add_u32 v25, v24 offset:48
    s_mov_b64 exec, -1
    s_bitcmp1_b32 s80, 2
    s_cbranch_scc1 L_fin
    s_mov_b32 s63, 0
    s_mov_b64 exec, s[68:69]
    buffer_load_dwordx4 v[64:67], v26, s[44:47], s57 offen offset:0 sc1
    s_mov_b64 exec, s[70:71]
    buffer_load_dwordx4 v[68:71], v26, s[44:47], s57 offen offset:1024 sc1
    s_mov_b64 exec, s[72:73]
    buffer_load_dwordx4 v[72:75], v26, s[44:47], s57 offen offset:2048 sc1
    s_mov_b64 exec, s[74:75]
    buffer_load_dwordx4 v[76:79], v26, s[44:47], s57 offen offset:3072 sc1
    s_not_b64 exec, s[68:69]
    v_mov_b32 v64, v32
    v_mov_b32 v65, v33
    v_mov_b32 v66, v34
    v_mov_b32 v67, v35
    s_not_b64 exec, s[70:71]
    v_mov_b32 v68, v32
    v_mov_b32 v69, v33
    v_mov_b32 v70, v34
    v_mov_b32 v71, v35
    s_not_b64 exec, s[72:73]
    v_mov_b32 v72, v32
    v_mov_b32 v73, v33
    v_mov_b32 v74, v34
    v_mov_b32 v75, v35
    s_not_b64 exec, s[74:75]
    v_mov_b32 v76, v32
    v_mov_b32 v77, v33
    v_mov_b32 v78, v34
    v_mov_b32 v79, v35
    s_mov_b64 exec, -1
L_poll26:
    s_waitcnt vmcnt(0)
    v_cmp_ne_u32 s[68:69], s34, v67
    v_cmp_ne_u32 s[70:71], s34, v71
    v_cmp_ne_u32 s[72:73], s34, v75
    v_cmp_ne_u32 s[74:75], s34, v79
    s_or_b64 vcc, s[68:69], s[70:71]
    s_or_b64 vcc, vcc, s[72:73]
    s_or_b64 vcc, vcc, s[74:75]
    s_cbranch_scc0 L_poll26_ok
    s_mov_b64 exec, s[68:69]
    buffer_load_dwordx4 v[64:67], v26, s[44:47], s57 offen offset:0 sc1
    s_mov_b64 exec, s[70:71]
    buffer_load_dwordx4 v[68:71], v26, s[44:47], s57 offen offset:1024 sc1
    s_mov_b64 exec, s[72:73]
    buffer_load_dwordx4 v[72:75], v26, s[44:47], s57 offen offset:2048 sc1
    s_mov_b64 exec, s[74:75]
    buffer_load_dwordx4 v[76:79], v26, s[44:47], s57 offen offset:3072 sc1
    s_mov_b64 exec, -1
    s_add_u32 s63, s63, 1
    s_cmp_lt_u32 s63, 200000
    s_cbranch_scc1 L_poll26
    s_waitcnt vmcnt(0)
L_poll26_ok:
    v_max3_f32 v28, v66, v70, v74
    v_max_f32 v28, v28, v78
    v_mov_b32 v29, v28
    s_nop 1
    v_permlane32_swap_b32 v28, v29
    v_max_f32 v28, v28, v29
    v_sub_f32 v66, v66, v28
    v_sub_f32 v70, v70, v28
    v_sub_f32 v74, v74, v28
    v_sub_f32 v78, v78, v28
    v_exp_f32 v66, v66
    v_exp_f32 v70, v70
    v_exp_f32 v74, v74
    v_exp_f32 v78, v78
    v_cvt_pk_bf16_f32 v22, v66, v70
    v_cvt_pk_bf16_f32 v23, v74, v78
    v_perm_b32 v40, v22, v22, v60
    v_perm_b32 v41, v22, v22, v62
    v_perm_b32 v42, v22, v22, v61
    v_perm_b32 v43, v22, v22, v63
    v_perm_b32 v44, v23, v23, v60
    v_perm_b32 v45, v23, v23, v62
    v_perm_b32 v46, v23, v23, v61
    v_perm_b32 v47, v23, v23, v63
    v_mfma_f32_16x16x16_bf16 v[28:31], v[40:41], v[64:65], 0
    v_mfma_f32_16x16x16_bf16 v[28:31], v[42:43], v[68:69], v[28:31]
    v_mfma_f32_16x16x16_bf16 v[28:31], v[44:45], v[72:73], v[28:31]
    v_mfma_f32_16x16x16_bf16 v[28:31], v[46:47], v[76:77], v[28:31]
    v_lshlrev_b32 v48, 16, v22
    v_and_b32 v49, 0xffff0000, v22
    v_lshlrev_b32 v50, 16, v23
    v_and_b32 v51, 0xffff0000, v23
    v_add_f32 v48, v48, v49
    v_add_f32 v50, v50, v51
    v_add_f32 v39, v48, v50
    v_mov_b32 v48, v39
    v_cndmask_b32 v32, v30, v28, s[66:67]
    v_cndmask_b32 v33, v31, v29, s[66:67]
    v_permlane32_swap_b32 v39, v48
    v_cvt_pk_bf16_f32 v24, v32, v33
    v_add_f32 v39, v39, v48
    ds_write_b32 v15, v24
    v_rcp_f32 v39, v39
    s_mov_b64 exec, 1
    ds_write_b32 v25, v39 offset:36
    s_mov_b64 exec, -1
    s_branch L_fin
L_w7:
    s_cmp_eq_u32 s33, 7
    s_cbranch_scc1 L_acu
    s_barrier
    s_waitcnt lgkmcnt(0)
    s_branch L_idle
L_acu:
    s_waitcnt lgkmcnt(0)
    s_barrier
    s_mov_b32 s44, s30
    s_mov_b32 s45, s31
    s_mov_b32 s46, 0x200000
    s_mov_b32 s47, 0x20000
    s_load_dword s35, s[30:31], 4
    s_branch L_acu_ld
L_acu_w45:
    s_and_b32 s56, s33, 3
    s_mul_i32 s56, s56, 5
    s_xor_b32 s32, s32, s56
L_acu_ld:
    s_mov_b32 s36, s6
    s_mov_b32 s37, s7
    s_mov_b32 s38, 0x800000
    s_mov_b32 s39, 0x20000
    s_and_b32 s66, s32, 7
    s_lshr_b32 s56, s32, 4
    s_lshl_b32 s56, s56, 3
    s_add_u32 s66, s66, s56
    s_bfe_u32 s67, s32, 65539
    s_lshl_b32 s61, s66, 19
    s_lshl_b32 s56, s3, 13
    s_add_u32 s61, s61, s56
    s_mul_i32 s62, s3, 8448
    s_lshl_b32 s57, s67, 16
    s_mul_i32 s58, s67, 67584
    s_add_u32 m0, s62, s58
    s_add_u32 s56, s61, s57
    buffer_load_dwordx4 v26, s[36:39], s56 offen  lds
    s_add_u32 m0, m0, 1056
    s_addk_i32 s56, 1024
    buffer_load_dwordx4 v26, s[36:39], s56 offen  lds
    s_add_u32 m0, m0, 1056
    s_addk_i32 s56, 1024
    buffer_load_dwordx4 v26, s[36:39], s56 offen  lds
    s_add_u32 m0, m0, 1056
    s_addk_i32 s56, 1024
    buffer_load_dwordx4 v26, s[36:39], s56 offen  lds
    s_add_u32 m0, m0, 1056
    s_addk_i32 s56, 1024
    buffer_load_dwordx4 v26, s[36:39], s56 offen  lds
    s_add_u32 m0, m0, 1056
    s_addk_i32 s56, 1024
    buffer_load_dwordx4 v26, s[36:39], s56 offen  lds
    s_add_u32 m0, m0, 1056
    s_addk_i32 s56, 1024
    buffer_load_dwordx4 v26, s[36:39], s56 offen  lds
    s_add_u32 m0, m0, 1056
    s_addk_i32 s56, 1024
    buffer_load_dwordx4 v26, s[36:39], s56 offen  lds
    s_xor_b32 s57, s57, 0x10000
    s_sub_u32 s58, 67584, s58
    s_add_u32 m0, s62, s58
    s_add_u32 s56, s61, s57
    buffer_load_dwordx4 v26, s[36:39], s56 offen  lds
    s_add_u32 m0, m0, 1056
    s_addk_i32 s56, 1024
    buffer_load_dwordx4 v26, s[36:39], s56 offen  lds
    s_add_u32 m0, m0, 1056
    s_addk_i32 s56, 1024
    buffer_load_dwordx4 v26, s[36:39], s56 offen  lds
    s_add_u32 m0, m0, 1056
    s_addk_i32 s56, 1024
    buffer_load_dwordx4 v26, s[36:39], s56 offen  lds
    s_add_u32 m0, m0, 1056
    s_addk_i32 s56, 1024
    buffer_load_dwordx4 v26, s[36:39], s56 offen  lds
    s_add_u32 m0, m0, 1056
    s_addk_i32 s56, 1024
    buffer_load_dwordx4 v26, s[36:39], s56 offen  lds
    s_add_u32 m0, m0, 1056
    s_addk_i32 s56, 1024
    buffer_load_dwordx4 v26, s[36:39], s56 offen  lds
    s_add_u32 m0, m0, 1056
    s_addk_i32 s56, 1024
    buffer_load_dwordx4 v26, s[36:39], s56 offen  lds
    s_add_u32 s56, s61, 196608
    buffer_load_dwordx4 v[32:35], v26, s[36:39], s56 offen offset:0
    buffer_load_dwordx4 v[36:39], v26, s[36:39], s56 offen offset:1024
    buffer_load_dwordx4 v[40:43], v26, s[36:39], s56 offen offset:2048
    buffer_load_dwordx4 v[44:47], v26, s[36:39], s56 offen offset:3072
    s_add_u32 s56, s61, 200704
    buffer_load_dwordx4 v[48:51], v26, s[36:39], s56 offen offset:0
    buffer_load_dwordx4 v[52:55], v26, s[36:39], s56 offen offset:1024
    buffer_load_dwordx4 v[56:59], v26, s[36:39], s56 offen offset:2048
    buffer_load_dwordx4 v[60:63], v26, s[36:39], s56 offen offset:3072
    s_waitcnt lgkmcnt(0)
    s_setprio 0
    s_add_u32 s35, s35, 0x9e3779b9
    s_cmp_eq_u32 s3, 6
    s_cbranch_scc0 L_gp
    s_and_b32 s57, s32, 7
    s_lshl_b32 s57, s57, 8
    s_lshl_b32 s56, s67, 15
    s_add_u32 s57, s57, s56
    s_add_u32 s57, s57, 65536
    s_add_u32 s64, s30, s57
    s_addc_u32 s65, s31, 0
    s_mov_b32 s63, 0
L_pre27:
    s_load_dword s68, s[64:65], 8 glc
    s_load_dword s69, s[64:65], 4104 glc
    s_load_dword s70, s[64:65], 8200 glc
    s_load_dword s71, s[64:65], 12296 glc
    s_load_dword s72, s[64:65], 16392 glc
    s_load_dword s73, s[64:65], 20488 glc
    s_load_dword s74, s[64:65], 24584 glc
    s_load_dword s75, s[64:65], 28680 glc
    s_mov_b32 s59, 0
    s_add_u32 s63, s63, 1
    s_waitcnt lgkmcnt(0)
    s_cmp_lg_u32 s68, s35
    s_addc_u32 s59, s59, 0
    s_cmp_lg_u32 s69, s35
    s_addc_u32 s59, s59, 0
    s_cmp_lg_u32 s70, s35
    s_addc_u32 s59, s59, 0
    s_cmp_lg_u32 s71, s35
    s_addc_u32 s59, s59, 0
    s_cmp_lg_u32 s72, s35
    s_addc_u32 s59, s59, 0
    s_cmp_lg_u32 s73, s35
    s_addc_u32 s59, s59, 0
    s_cmp_lg_u32 s74, s35
    s_addc_u32 s59, s59, 0
    s_cmp_lg_u32 s75, s35
    s_addc_u32 s59, s59, 0
    s_cmp_le_u32 s59, 0
    s_cbranch_scc1 L_pre27_ok
    s_sleep 4
    s_cmp_lt_u32 s63, 200000
    s_cbranch_scc1 L_pre27
L_pre27_ok:
L_gp:
    s_barrier
    s_lshl_b32 s57, s3, 12
    s_lshl_b32 s56, s67, 15
    s_add_u32 s57, s57, s56
    s_add_u32 s57, s57, 65536
    s_mul_i32 s56, s3, 2112
    s_add_u32 s56, s56, 143360
    v_lshl_add_u32 v13, v0, 3, s56
    s_mov_b32 s63, 0
    buffer_load_dwordx3 v[192:194], v26, s[44:47], s57 offen offset:0 sc1
    buffer_load_dwordx3 v[196:198], v26, s[44:47], s57 offen offset:1024 sc1
    buffer_load_dwordx3 v[200:202], v26, s[44:47], s57 offen offset:2048 sc1
    buffer_load_dwordx3 v[204:206], v26, s[44:47], s57 offen offset:3072 sc1
L_poll28:
    s_waitcnt vmcnt(0)
    v_cmp_ne_u32 s[68:69], s35, v194
    v_cmp_ne_u32 s[70:71], s35, v198
    v_cmp_ne_u32 s[72:73], s35, v202
    v_cmp_ne_u32 s[74:75], s35, v206
    s_or_b64 vcc, s[68:69], s[70:71]
    s_or_b64 vcc, vcc, s[72:73]
    s_or_b64 vcc, vcc, s[74:75]
    s_cbranch_scc0 L_poll28_ok
    s_sleep 16
    s_mov_b64 exec, s[68:69]
    buffer_load_dwordx3 v[192:194], v26, s[44:47], s57 offen offset:0 sc1
    s_mov_b64 exec, s[70:71]
    buffer_load_dwordx3 v[196:198], v26, s[44:47], s57 offen offset:1024 sc1
    s_mov_b64 exec, s[72:73]
    buffer_load_dwordx3 v[200:202], v26, s[44:47], s57 offen offset:2048 sc1
    s_mov_b64 exec, s[74:75]
    buffer_load_dwordx3 v[204:206], v26, s[44:47], s57 offen offset:3072 sc1
    s_mov_b64 exec, -1
    s_add_u32 s63, s63, 1
    s_cmp_lt_u32 s63, 200000
    s_cbranch_scc1 L_poll28
    s_waitcnt vmcnt(0)
L_poll28_ok:
    ds_write_b64 v13, v[192:193] offset:0
    ds_write_b64 v13, v[196:197] offset:512
    ds_write_b64 v13, v[200:201] offset:1056
    ds_write_b64 v13, v[204:205] offset:1568
    s_movk_i32 s59, 1056
    v_mul_lo_u32 v24, v11, s59
    v_lshl_add_u32 v24, v12, 4, v24
    s_mul_i32 s56, s3, 16896
    v_add_u32 v14, s56, v24
    v_add_u32 v31, 143360, v24
    v_lshrrev_b32 v24, 2, v0
    v_mul_lo_u32 v24, v24, s59
    v_and_b32 v30, 3, v0
    v_lshl_add_u32 v24, v30, 3, v24
    s_lshl_b32 s56, s3, 7
    v_add_u32 v16, s56, v24
    v_add_u32 v17, 67584, v16
    v_lshlrev_b32 v24, 5, v11
    v_add_u32 v19, 137216, v24
    s_lshl_b32 s56, s3, 2
    v_add_u32 v18, s56, v19
    v_add_u32 v22, 143360, v26
    s_lshr_b32 s56, s3, 1
    s_lshl_b32 s56, s56, 10
    s_and_b32 s59, s3, 1
    s_lshl_b32 s59, s59, 3
    s_add_u32 s56, s56, s59
    v_add_u32 v21, s56, v22
    s_add_u32 s56, s62, 67584
    v_add_u32 v28, s56, v26
    s_waitcnt lgkmcnt(0)
    s_barrier
    ds_read_b128 v[128:131], v31 offset:0
    ds_read_b128 v[132:135], v31 offset:64
    ds_read_b128 v[136:139], v31 offset:128
    ds_read_b128 v[140:143], v31 offset:192
    ds_read_b128 v[144:147], v31 offset:256
    ds_read_b128 v[148:151], v31 offset:320
    ds_read_b128 v[152:155], v31 offset:384
    ds_read_b128 v[156:159], v31 offset:448
    ds_read_b128 v[160:163], v31 offset:512
    ds_read_b128 v[164:167], v31 offset:576
    ds_read_b128 v[168:171], v31 offset:640
    ds_read_b128 v[172:175], v31 offset:704
    ds_read_b128 v[176:179], v31 offset:768
    ds_read_b128 v[180:183], v31 offset:832
    ds_read_b128 v[184:187], v31 offset:896
    ds_read_b128 v[188:191], v31 offset:960
    ds_read_b128 v[192:195], v14 offset:0
    ds_read_b128 v[196:199], v14 offset:64
    ds_read_b128 v[200:203], v14 offset:128
    ds_read_b128 v[204:207], v14 offset:192
    ds_read_b128 v[208:211], v14 offset:256
    ds_read_b128 v[212:215], v14 offset:320
    ds_read_b128 v[216:219], v14 offset:384
    ds_read_b128 v[220:223], v14 offset:448
    s_waitcnt lgkmcnt(7)
    v_mfma_f32_16x16x32_bf16 v[64:67], v[192:195], v[128:131], 0
    ds_read_b128 v[224:227], v14 offset:512
    s_waitcnt lgkmcnt(7)
    v_mfma_f32_16x16x32_bf16 v[64:67], v[196:199], v[132:135], v[64:67]
    ds_read_b128 v[228:231], v14 offset:576
    s_waitcnt lgkmcnt(7)
    v_mfma_f32_16x16x32_bf16 v[64:67], v[200:203], v[136:139], v[64:67]
    ds_read_b128 v[232:235], v14 offset:640
    s_waitcnt lgkmcnt(7)
    v_mfma_f32_16x16x32_bf16 v[64:67], v[204:207], v[140:143], v[64:67]
    ds_read_b128 v[236:239], v14 offset:704
    s_waitcnt lgkmcnt(7)
    v_mfma_f32_16x16x32_bf16 v[64:67], v[208:211], v[144:147], v[64:67]
    ds_read_b128 v[240:243], v14 offset:768
    s_waitcnt lgkmcnt(7)
    v_mfma_f32_16x16x32_bf16 v[64:67], v[212:215], v[148:151], v[64:67]
    ds_read_b128 v[244:247], v14 offset:832
    s_waitcnt lgkmcnt(7)
    v_mfma_f32_16x16x32_bf16 v[64:67], v[216:219], v[152:155], v[64:67]
    ds_read_b128 v[248:251], v14 offset:896
    s_waitcnt lgkmcnt(7)
    v_mfma_f32_16x16x32_bf16 v[64:67], v[220:223], v[156:159], v[64:67]
    ds_read_b128 v[252:255], v14 offset:960
    s_waitcnt lgkmcnt(7)
    v_mfma_f32_16x16x32_bf16 v[64:67], v[224:227], v[160:163], v[64:67]
    s_waitcnt lgkmcnt(6)
    v_mfma_f32_16x16x32_bf16 v[64:67], v[228:231], v[164:167], v[64:67]
    s_waitcnt lgkmcnt(5)
    v_mfma_f32_16x16x32_bf16 v[64:67], v[232:235], v[168:171], v[64:67]
    s_waitcnt lgkmcnt(4)
    v_mfma_f32_16x16x32_bf16 v[64:67], v[236:239], v[172:175], v[64:67]
    s_waitcnt lgkmcnt(3)
    v_mfma_f32_16x16x32_bf16 v[64:67], v[240:243], v[176:179], v[64:67]
    s_waitcnt lgkmcnt(2)
    v_mfma_f32_16x16x32_bf16 v[64:67], v[244:247], v[180:183], v[64:67]
    s_waitcnt lgkmcnt(1)
    v_mfma_f32_16x16x32_bf16 v[64:67], v[248:251], v[184:187], v[64:67]
    s_waitcnt lgkmcnt(0)
    v_mfma_f32_16x16x32_bf16 v[64:67], v[252:255], v[188:191], v[64:67]
    ds_read_b64_tr_b16 v[192:193], v16 offset:0
    ds_read_b64_tr_b16 v[194:195], v16 offset:16896
    ds_read_b64_tr_b16 v[196:197], v16 offset:33792
    ds_read_b64_tr_b16 v[198:199], v16 offset:50688
    ds_read_b64_tr_b16 v[200:201], v17 offset:0
    ds_read_b64_tr_b16 v[202:203], v17 offset:16896
    ds_read_b64_tr_b16 v[204:205], v17 offset:33792
    ds_read_b64_tr_b16 v[206:207], v17 offset:50688
    v_max3_f32 v24, v64, v65, v66
    v_max_f32 v24, v24, v67
    v_mov_b32 v30, v24
    s_nop 1
    v_permlane32_swap_b32 v24, v30
    v_max_f32 v24, v24, v30
    v_mov_b32 v30, v24
    s_nop 1
    v_permlane16_swap_b32 v24, v30
    v_max_f32 v24, v24, v30
    s_mov_b64 exec, 0xffff
    ds_write_b32 v18, v24
    s_mov_b64 exec, -1
    s_waitcnt lgkmcnt(0)
    s_barrier
    ds_read_b128 v[72:75], v19
    ds_read_b128 v[76:79], v19 offset:16
    ds_read_b64_tr_b16 v[208:209], v16 offset:32
    ds_read_b64_tr_b16 v[210:211], v16 offset:16928
    ds_read_b64_tr_b16 v[212:213], v16 offset:33824
    ds_read_b64_tr_b16 v[214:215], v16 offset:50720
    ds_read_b64_tr_b16 v[216:217], v17 offset:32
    ds_read_b64_tr_b16 v[218:219], v17 offset:16928
    ds_read_b64_tr_b16 v[220:221], v17 offset:33824
    ds_read_b64_tr_b16 v[222:223], v17 offset:50720
    ds_read_b64_tr_b16 v[224:225], v16 offset:64
    ds_read_b64_tr_b16 v[226:227], v16 offset:16960
    ds_read_b64_tr_b16 v[228:229], v16 offset:33856
    ds_read_b64_tr_b16 v[230:231], v16 offset:50752
    s_waitcnt lgkmcnt(12)
    v_max3_f32 v72, v72, v73, v74
    v_max3_f32 v75, v75, v76, v77
    v_max3_f32 v72, v72, v78, v79
    v_max_f32 v68, v72, v75
    v_mul_f32 v24, s60, v68
    v_fma_f32 v64, v64, s60, -v24
    v_fma_f32 v65, v65, s60, -v24
    v_fma_f32 v66, v66, s60, -v24
    v_fma_f32 v67, v67, s60, -v24
    v_exp_f32 v64, v64
    v_exp_f32 v65, v65
    v_exp_f32 v66, v66
    v_exp_f32 v67, v67
    v_cvt_pk_bf16_f32 v30, v64, v65
    v_cvt_pk_bf16_f32 v31, v66, v67
    ds_write_b64 v21, v[30:31]
    ds_read_b64_tr_b16 v[232:233], v17 offset:64
    ds_read_b64_tr_b16 v[234:235], v17 offset:16960
    ds_read_b64_tr_b16 v[236:237], v17 offset:33856
    ds_read_b64_tr_b16 v[238:239], v17 offset:50752
    ds_read_b64_tr_b16 v[240:241], v16 offset:96
    ds_read_b64_tr_b16 v[242:243], v16 offset:16992
    ds_read_b64_tr_b16 v[244:245], v16 offset:33888
    ds_read_b64_tr_b16 v[246:247], v16 offset:50784
    ds_read_b64_tr_b16 v[248:249], v17 offset:96
    ds_read_b64_tr_b16 v[250:251], v17 offset:16992
    ds_read_b64_tr_b16 v[252:253], v17 offset:33888
    ds_read_b64_tr_b16 v[254:255], v17 offset:50784
    v_add_f32 v64, v64, v65
    v_add_f32 v66, v66, v67
    v_add_f32 v92, v64, v66
    s_waitcnt vmcnt(0) lgkmcnt(0)
    s_barrier
    ds_read_b128 v[72:75], v22 offset:0
    ds_read_b128 v[76:79], v22 offset:1024
    ds_read_b128 v[80:83], v22 offset:2048
    ds_read_b128 v[84:87], v22 offset:3072
    s_add_u32 m0, s62, 0
    s_add_u32 s56, s61, 131072
    buffer_load_dwordx4 v26, s[36:39], s56 offen  lds
    s_add_u32 m0, m0, 1056
    s_addk_i32 s56, 1024
    buffer_load_dwordx4 v26, s[36:39], s56 offen  lds
    s_add_u32 m0, m0, 1056
    s_addk_i32 s56, 1024
    buffer_load_dwordx4 v26, s[36:39], s56 offen  lds
    s_add_u32 m0, m0, 1056
    s_addk_i32 s56, 1024
    buffer_load_dwordx4 v26, s[36:39], s56 offen  lds
    s_add_u32 m0, m0, 1056
    s_addk_i32 s56, 1024
    buffer_load_dwordx4 v26, s[36:39], s56 offen  lds
    s_add_u32 m0, m0, 1056
    s_addk_i32 s56, 1024
    buffer_load_dwordx4 v26, s[36:39], s56 offen  lds
    s_add_u32 m0, m0, 1056
    s_addk_i32 s56, 1024
    buffer_load_dwordx4 v26, s[36:39], s56 offen  lds
    s_add_u32 m0, m0, 1056
    s_addk_i32 s56, 1024
    buffer_load_dwordx4 v26, s[36:39], s56 offen  lds
    ds_write_b128 v28, v[32:35] offset:0
    ds_write_b128 v28, v[36:39] offset:1056
    ds_write_b128 v28, v[40:43] offset:2112
    ds_write_b128 v28, v[44:47] offset:3168
    ds_write_b128 v28, v[48:51] offset:4224
    ds_write_b128 v28, v[52:55] offset:5280
    ds_write_b128 v28, v[56:59] offset:6336
    ds_write_b128 v28, v[60:63] offset:7392
    s_waitcnt lgkmcnt(11)
    v_mfma_f32_16x16x32_bf16 v[96:99], v[192:195], v[72:75], 0
    v_mfma_f32_16x16x32_bf16 v[100:103], v[208:211], v[72:75], 0
    v_mfma_f32_16x16x32_bf16 v[104:107], v[224:227], v[72:75], 0
    v_mfma_f32_16x16x32_bf16 v[108:111], v[240:243], v[72:75], 0
    s_waitcnt lgkmcnt(10)
    v_mfma_f32_16x16x32_bf16 v[96:99], v[196:199], v[76:79], v[96:99]
    v_mfma_f32_16x16x32_bf16 v[100:103], v[212:215], v[76:79], v[100:103]
    v_mfma_f32_16x16x32_bf16 v[104:107], v[228:231], v[76:79], v[104:107]
    v_mfma_f32_16x16x32_bf16 v[108:111], v[244:247], v[76:79], v[108:111]
    s_waitcnt lgkmcnt(9)
    v_mfma_f32_16x16x32_bf16 v[96:99], v[200:203], v[80:83], v[96:99]
    v_mfma_f32_16x16x32_bf16 v[100:103], v[216:219], v[80:83], v[100:103]
    v_mfma_f32_16x16x32_bf16 v[104:107], v[232:235], v[80:83], v[104:107]
    v_mfma_f32_16x16x32_bf16 v[108:111], v[248:251], v[80:83], v[108:111]
    s_waitcnt lgkmcnt(8)
    v_mfma_f32_16x16x32_bf16 v[96:99], v[204:207], v[84:87], v[96:99]
    v_mfma_f32_16x16x32_bf16 v[100:103], v[220:223], v[84:87], v[100:103]
    v_mfma_f32_16x16x32_bf16 v[104:107], v[236:239], v[84:87], v[104:107]
    v_mfma_f32_16x16x32_bf16 v[108:111], v[252:255], v[84:87], v[108:111]
    s_waitcnt lgkmcnt(0)
    s_add_u32 s56, s61, 327680
    buffer_load_dwordx4 v[32:35], v26, s[36:39], s56 offen offset:0
    buffer_load_dwordx4 v[36:39], v26, s[36:39], s56 offen offset:1024
    buffer_load_dwordx4 v[40:43], v26, s[36:39], s56 offen offset:2048
    buffer_load_dwordx4 v[44:47], v26, s[36:39], s56 offen offset:3072
    s_add_u32 s56, s61, 331776
    buffer_load_dwordx4 v[48:51], v26, s[36:39], s56 offen offset:0
    buffer_load_dwordx4 v[52:55], v26, s[36:39], s56 offen offset:1024
    buffer_load_dwordx4 v[56:59], v26, s[36:39], s56 offen offset:2048
    buffer_load_dwordx4 v[60:63], v26, s[36:39], s56 offen offset:3072
    s_waitcnt vmcnt(8)
    s_barrier
    ds_read_b128 v[192:195], v14 offset:0
    ds_read_b128 v[196:199], v14 offset:64
    ds_read_b128 v[200:203], v14 offset:128
    ds_read_b128 v[204:207], v14 offset:192
    ds_read_b128 v[208:211], v14 offset:256
    ds_read_b128 v[212:215], v14 offset:320
    ds_read_b128 v[216:219], v14 offset:384
    ds_read_b128 v[220:223], v14 offset:448
    s_waitcnt lgkmcnt(7)
    v_mfma_f32_16x16x32_bf16 v[64:67], v[192:195], v[128:131], 0
    ds_read_b128 v[224:227], v14 offset:512
    s_waitcnt lgkmcnt(7)
    v_mfma_f32_16x16x32_bf16 v[64:67], v[196:199], v[132:135], v[64:67]
    ds_read_b128 v[228:231], v14 offset:576
    s_waitcnt lgkmcnt(7)
    v_mfma_f32_16x16x32_bf16 v[64:67], v[200:203], v[136:139], v[64:67]
    ds_read_b128 v[232:235], v14 offset:640
    s_waitcnt lgkmcnt(7)
    v_mfma_f32_16x16x32_bf16 v[64:67], v[204:207], v[140:143], v[64:67]
    ds_read_b128 v[236:239], v14 offset:704
    s_waitcnt lgkmcnt(7)
    v_mfma_f32_16x16x32_bf16 v[64:67], v[208:211], v[144:147], v[64:67]
    ds_read_b128 v[240:243], v14 offset:768
    s_waitcnt lgkmcnt(7)
    v_mfma_f32_16x16x32_bf16 v[64:67], v[212:215], v[148:151], v[64:67]
    ds_read_b128 v[244:247], v14 offset:832
    s_waitcnt lgkmcnt(7)
    v_mfma_f32_16x16x32_bf16 v[64:67], v[216:219], v[152:155], v[64:67]
    ds_read_b128 v[248:251], v14 offset:896
    s_waitcnt lgkmcnt(7)
    v_mfma_f32_16x16x32_bf16 v[64:67], v[220:223], v[156:159], v[64:67]
    ds_read_b128 v[252:255], v14 offset:960
    s_waitcnt lgkmcnt(7)
    v_mfma_f32_16x16x32_bf16 v[64:67], v[224:227], v[160:163], v[64:67]
    s_waitcnt lgkmcnt(6)
    v_mfma_f32_16x16x32_bf16 v[64:67], v[228:231], v[164:167], v[64:67]
    s_waitcnt lgkmcnt(5)
    v_mfma_f32_16x16x32_bf16 v[64:67], v[232:235], v[168:171], v[64:67]
    s_waitcnt lgkmcnt(4)
    v_mfma_f32_16x16x32_bf16 v[64:67], v[236:239], v[172:175], v[64:67]
    s_waitcnt lgkmcnt(3)
    v_mfma_f32_16x16x32_bf16 v[64:67], v[240:243], v[176:179], v[64:67]
    s_waitcnt lgkmcnt(2)
    v_mfma_f32_16x16x32_bf16 v[64:67], v[244:247], v[180:183], v[64:67]
    s_waitcnt lgkmcnt(1)
    v_mfma_f32_16x16x32_bf16 v[64:67], v[248:251], v[184:187], v[64:67]
    s_waitcnt lgkmcnt(0)
    v_mfma_f32_16x16x32_bf16 v[64:67], v[252:255], v[188:191], v[64:67]
    ds_read_b64_tr_b16 v[192:193], v16 offset:0
    ds_read_b64_tr_b16 v[194:195], v16 offset:16896
    ds_read_b64_tr_b16 v[196:197], v16 offset:33792
    ds_read_b64_tr_b16 v[198:199], v16 offset:50688
    ds_read_b64_tr_b16 v[200:201], v17 offset:0
    ds_read_b64_tr_b16 v[202:203], v17 offset:16896
    ds_read_b64_tr_b16 v[204:205], v17 offset:33792
    ds_read_b64_tr_b16 v[206:207], v17 offset:50688
    v_max3_f32 v24, v64, v65, v66
    v_max_f32 v24, v24, v67
    v_mov_b32 v30, v24
    s_nop 1
    v_permlane32_swap_b32 v24, v30
    v_max_f32 v24, v24, v30
    v_mov_b32 v30, v24
    s_nop 1
    v_permlane16_swap_b32 v24, v30
    v_max_f32 v24, v24, v30
    s_mov_b64 exec, 0xffff
    ds_write_b32 v18, v24
    s_mov_b64 exec, -1
    s_waitcnt lgkmcnt(0)
    s_barrier
    ds_read_b128 v[72:75], v19
    ds_read_b128 v[76:79], v19 offset:16
    ds_read_b64_tr_b16 v[208:209], v16 offset:32
    ds_read_b64_tr_b16 v[210:211], v16 offset:16928
    ds_read_b64_tr_b16 v[212:213], v16 offset:33824
    ds_read_b64_tr_b16 v[214:215], v16 offset:50720
    ds_read_b64_tr_b16 v[216:217], v17 offset:32
    ds_read_b64_tr_b16 v[218:219], v17 offset:16928
    ds_read_b64_tr_b16 v[220:221], v17 offset:33824
    ds_read_b64_tr_b16 v[222:223], v17 offset:50720
    ds_read_b64_tr_b16 v[224:225], v16 offset:64
    ds_read_b64_tr_b16 v[226:227], v16 offset:16960
    ds_read_b64_tr_b16 v[228:229], v16 offset:33856
    ds_read_b64_tr_b16 v[230:231], v16 offset:50752
    s_waitcnt lgkmcnt(12)
    v_max3_f32 v72, v72, v73, v74
    v_max3_f32 v75, v75, v76, v77
    v_max3_f32 v72, v72, v78, v79
    v_max3_f32 v72, v72, v75, v68
    v_sub_f32 v88, v68, v72
    v_mov_b32 v68, v72
    v_mul_f32 v88, s60, v88
    v_exp_f32 v88, v88
    v_mul_f32 v24, s60, v68
    v_fma_f32 v64, v64, s60, -v24
    v_fma_f32 v65, v65, s60, -v24
    v_fma_f32 v66, v66, s60, -v24
    v_fma_f32 v67, v67, s60, -v24
    v_exp_f32 v64, v64
    v_exp_f32 v65, v65
    v_exp_f32 v66, v66
    v_exp_f32 v67, v67
    v_cvt_pk_bf16_f32 v30, v64, v65
    v_cvt_pk_bf16_f32 v31, v66, v67
    ds_write_b64 v21, v[30:31]
    ds_read_b64_tr_b16 v[232:233], v17 offset:64
    ds_read_b64_tr_b16 v[234:235], v17 offset:16960
    ds_read_b64_tr_b16 v[236:237], v17 offset:33856
    ds_read_b64_tr_b16 v[238:239], v17 offset:50752
    ds_read_b64_tr_b16 v[240:241], v16 offset:96
    ds_read_b64_tr_b16 v[242:243], v16 offset:16992
    ds_read_b64_tr_b16 v[244:245], v16 offset:33888
    ds_read_b64_tr_b16 v[246:247], v16 offset:50784
    ds_read_b64_tr_b16 v[248:249], v17 offset:96
    ds_read_b64_tr_b16 v[250:251], v17 offset:16992
    ds_read_b64_tr_b16 v[252:253], v17 offset:33888
    ds_read_b64_tr_b16 v[254:255], v17 offset:50784
    v_add_f32 v64, v64, v65
    v_add_f32 v66, v66, v67
    v_fma_f32 v92, v92, v88, v64
    v_add_f32 v92, v92, v66
    v_pk_mul_f32 v[96:97], v[96:97], v[88:89] op_sel_hi:[1,0]
    v_pk_mul_f32 v[98:99], v[98:99], v[88:89] op_sel_hi:[1,0]
    v_pk_mul_f32 v[100:101], v[100:101], v[88:89] op_sel_hi:[1,0]
    v_pk_mul_f32 v[102:103], v[102:103], v[88:89] op_sel_hi:[1,0]
    v_pk_mul_f32 v[104:105], v[104:105], v[88:89] op_sel_hi:[1,0]
    v_pk_mul_f32 v[106:107], v[106:107], v[88:89] op_sel_hi:[1,0]
    v_pk_mul_f32 v[108:109], v[108:109], v[88:89] op_sel_hi:[1,0]
    v_pk_mul_f32 v[110:111], v[110:111], v[88:89] op_sel_hi:[1,0]
    s_waitcnt vmcnt(0) lgkmcnt(0)
    s_barrier
    ds_read_b128 v[72:75], v22 offset:0
    ds_read_b128 v[76:79], v22 offset:1024
    ds_read_b128 v[80:83], v22 offset:2048
    ds_read_b128 v[84:87], v22 offset:3072
    s_add_u32 m0, s62, 0
    s_add_u32 s56, s61, 262144
    buffer_load_dwordx4 v26, s[36:39], s56 offen  lds
    s_add_u32 m0, m0, 1056
    s_addk_i32 s56, 1024
    buffer_load_dwordx4 v26, s[36:39], s56 offen  lds
    s_add_u32 m0, m0, 1056
    s_addk_i32 s56, 1024
    buffer_load_dwordx4 v26, s[36:39], s56 offen  lds
    s_add_u32 m0, m0, 1056
    s_addk_i32 s56, 1024
    buffer_load_dwordx4 v26, s[36:39], s56 offen  lds
    s_add_u32 m0, m0, 1056
    s_addk_i32 s56, 1024
    buffer_load_dwordx4 v26, s[36:39], s56 offen  lds
    s_add_u32 m0, m0, 1056
    s_addk_i32 s56, 1024
    buffer_load_dwordx4 v26, s[36:39], s56 offen  lds
    s_add_u32 m0, m0, 1056
    s_addk_i32 s56, 1024
    buffer_load_dwordx4 v26, s[36:39], s56 offen  lds
    s_add_u32 m0, m0, 1056
    s_addk_i32 s56, 1024
    buffer_load_dwordx4 v26, s[36:39], s56 offen  lds
    ds_write_b128 v28, v[32:35] offset:0
    ds_write_b128 v28, v[36:39] offset:1056
    ds_write_b128 v28, v[40:43] offset:2112
    ds_write_b128 v28, v[44:47] offset:3168
    ds_write_b128 v28, v[48:51] offset:4224
    ds_write_b128 v28, v[52:55] offset:5280
    ds_write_b128 v28, v[56:59] offset:6336
    ds_write_b128 v28, v[60:63] offset:7392
    s_waitcnt lgkmcnt(11)
    v_mfma_f32_16x16x32_bf16 v[96:99], v[192:195], v[72:75], v[96:99]
    v_mfma_f32_16x16x32_bf16 v[100:103], v[208:211], v[72:75], v[100:103]
    v_mfma_f32_16x16x32_bf16 v[104:107], v[224:227], v[72:75], v[104:107]
    v_mfma_f32_16x16x32_bf16 v[108:111], v[240:243], v[72:75], v[108:111]
    s_waitcnt lgkmcnt(10)
    v_mfma_f32_16x16x32_bf16 v[96:99], v[196:199], v[76:79], v[96:99]
    v_mfma_f32_16x16x32_bf16 v[100:103], v[212:215], v[76:79], v[100:103]
    v_mfma_f32_16x16x32_bf16 v[104:107], v[228:231], v[76:79], v[104:107]
    v_mfma_f32_16x16x32_bf16 v[108:111], v[244:247], v[76:79], v[108:111]
    s_waitcnt lgkmcnt(9)
    v_mfma_f32_16x16x32_bf16 v[96:99], v[200:203], v[80:83], v[96:99]
    v_mfma_f32_16x16x32_bf16 v[100:103], v[216:219], v[80:83], v[100:103]
    v_mfma_f32_16x16x32_bf16 v[104:107], v[232:235], v[80:83], v[104:107]
    v_mfma_f32_16x16x32_bf16 v[108:111], v[248:251], v[80:83], v[108:111]
    s_waitcnt lgkmcnt(8)
    v_mfma_f32_16x16x32_bf16 v[96:99], v[204:207], v[84:87], v[96:99]
    v_mfma_f32_16x16x32_bf16 v[100:103], v[220:223], v[84:87], v[100:103]
    v_mfma_f32_16x16x32_bf16 v[104:107], v[236:239], v[84:87], v[104:107]
    v_mfma_f32_16x16x32_bf16 v[108:111], v[252:255], v[84:87], v[108:111]
    s_waitcnt lgkmcnt(0)
    s_add_u32 s56, s61, 458752
    buffer_load_dwordx4 v[32:35], v26, s[36:39], s56 offen offset:0
    buffer_load_dwordx4 v[36:39], v26, s[36:39], s56 offen offset:1024
    buffer_load_dwordx4 v[40:43], v26, s[36:39], s56 offen offset:2048
    buffer_load_dwordx4 v[44:47], v26, s[36:39], s56 offen offset:3072
    s_add_u32 s56, s61, 462848
    buffer_load_dwordx4 v[48:51], v26, s[36:39], s56 offen offset:0
    buffer_load_dwordx4 v[52:55], v26, s[36:39], s56 offen offset:1024
    buffer_load_dwordx4 v[56:59], v26, s[36:39], s56 offen offset:2048
    buffer_load_dwordx4 v[60:63], v26, s[36:39], s56 offen offset:3072
    s_waitcnt vmcnt(8)
    s_barrier
    ds_read_b128 v[192:195], v14 offset:0
    ds_read_b128 v[196:199], v14 offset:64
    ds_read_b128 v[200:203], v14 offset:128
    ds_read_b128 v[204:207], v14 offset:192
    ds_read_b128 v[208:211], v14 offset:256
    ds_read_b128 v[212:215], v14 offset:320
    ds_read_b128 v[216:219], v14 offset:384
    ds_read_b128 v[220:223], v14 offset:448
    s_waitcnt lgkmcnt(7)
    v_mfma_f32_16x16x32_bf16 v[64:67], v[192:195], v[128:131], 0
    ds_read_b128 v[224:227], v14 offset:512
    s_waitcnt lgkmcnt(7)
    v_mfma_f32_16x16x32_bf16 v[64:67], v[196:199], v[132:135], v[64:67]
    ds_read_b128 v[228:231], v14 offset:576
    s_waitcnt lgkmcnt(7)
    v_mfma_f32_16x16x32_bf16 v[64:67], v[200:203], v[136:139], v[64:67]
    ds_read_b128 v[232:235], v14 offset:640
    s_waitcnt lgkmcnt(7)
    v_mfma_f32_16x16x32_bf16 v[64:67], v[204:207], v[140:143], v[64:67]
    ds_read_b128 v[236:239], v14 offset:704
    s_waitcnt lgkmcnt(7)
    v_mfma_f32_16x16x32_bf16 v[64:67], v[208:211], v[144:147], v[64:67]
    ds_read_b128 v[240:243], v14 offset:768
    s_waitcnt lgkmcnt(7)
    v_mfma_f32_16x16x32_bf16 v[64:67], v[212:215], v[148:151], v[64:67]
    ds_read_b128 v[244:247], v14 offset:832
    s_waitcnt lgkmcnt(7)
    v_mfma_f32_16x16x32_bf16 v[64:67], v[216:219], v[152:155], v[64:67]
    ds_read_b128 v[248:251], v14 offset:896
    s_waitcnt lgkmcnt(7)
    v_mfma_f32_16x16x32_bf16 v[64:67], v[220:223], v[156:159], v[64:67]
    ds_read_b128 v[252:255], v14 offset:960
    s_waitcnt lgkmcnt(7)
    v_mfma_f32_16x16x32_bf16 v[64:67], v[224:227], v[160:163], v[64:67]
    s_waitcnt lgkmcnt(6)
    v_mfma_f32_16x16x32_bf16 v[64:67], v[228:231], v[164:167], v[64:67]
    s_waitcnt lgkmcnt(5)
    v_mfma_f32_16x16x32_bf16 v[64:67], v[232:235], v[168:171], v[64:67]
    s_waitcnt lgkmcnt(4)
    v_mfma_f32_16x16x32_bf16 v[64:67], v[236:239], v[172:175], v[64:67]
    s_waitcnt lgkmcnt(3)
    v_mfma_f32_16x16x32_bf16 v[64:67], v[240:243], v[176:179], v[64:67]
    s_waitcnt lgkmcnt(2)
    v_mfma_f32_16x16x32_bf16 v[64:67], v[244:247], v[180:183], v[64:67]
    s_waitcnt lgkmcnt(1)
    v_mfma_f32_16x16x32_bf16 v[64:67], v[248:251], v[184:187], v[64:67]
    s_waitcnt lgkmcnt(0)
    v_mfma_f32_16x16x32_bf16 v[64:67], v[252:255], v[188:191], v[64:67]
    ds_read_b64_tr_b16 v[192:193], v16 offset:0
    ds_read_b64_tr_b16 v[194:195], v16 offset:16896
    ds_read_b64_tr_b16 v[196:197], v16 offset:33792
    ds_read_b64_tr_b16 v[198:199], v16 offset:50688
    ds_read_b64_tr_b16 v[200:201], v17 offset:0
    ds_read_b64_tr_b16 v[202:203], v17 offset:16896
    ds_read_b64_tr_b16 v[204:205], v17 offset:33792
    ds_read_b64_tr_b16 v[206:207], v17 offset:50688
    v_max3_f32 v24, v64, v65, v66
    v_max_f32 v24, v24, v67
    v_mov_b32 v30, v24
    s_nop 1
    v_permlane32_swap_b32 v24, v30
    v_max_f32 v24, v24, v30
    v_mov_b32 v30, v24
    s_nop 1
    v_permlane16_swap_b32 v24, v30
    v_max_f32 v24, v24, v30
    s_mov_b64 exec, 0xffff
    ds_write_b32 v18, v24
    s_mov_b64 exec, -1
    s_waitcnt lgkmcnt(0)
    s_barrier
    ds_read_b128 v[72:75], v19
    ds_read_b128 v[76:79], v19 offset:16
    ds_read_b64_tr_b16 v[208:209], v16 offset:32
    ds_read_b64_tr_b16 v[210:211], v16 offset:16928
    ds_read_b64_tr_b16 v[212:213], v16 offset:33824
    ds_read_b64_tr_b16 v[214:215], v16 offset:50720
    ds_read_b64_tr_b16 v[216:217], v17 offset:32
    ds_read_b64_tr_b16 v[218:219], v17 offset:16928
    ds_read_b64_tr_b16 v[220:221], v17 offset:33824
    ds_read_b64_tr_b16 v[222:223], v17 offset:50720
    ds_read_b64_tr_b16 v[224:225], v16 offset:64
    ds_read_b64_tr_b16 v[226:227], v16 offset:16960
    ds_read_b64_tr_b16 v[228:229], v16 offset:33856
    ds_read_b64_tr_b16 v[230:231], v16 offset:50752
    s_waitcnt lgkmcnt(12)
    v_max3_f32 v72, v72, v73, v74
    v_max3_f32 v75, v75, v76, v77
    v_max3_f32 v72, v72, v78, v79
    v_max3_f32 v72, v72, v75, v68
    v_sub_f32 v88, v68, v72
    v_mov_b32 v68, v72
    v_mul_f32 v88, s60, v88
    v_exp_f32 v88, v88
    v_mul_f32 v24, s60, v68
    v_fma_f32 v64, v64, s60, -v24
    v_fma_f32 v65, v65, s60, -v24
    v_fma_f32 v66, v66, s60, -v24
    v_fma_f32 v67, v67, s60, -v24
    v_exp_f32 v64, v64
    v_exp_f32 v65, v65
    v_exp_f32 v66, v66
    v_exp_f32 v67, v67
    v_cvt_pk_bf16_f32 v30, v64, v65
    v_cvt_pk_bf16_f32 v31, v66, v67
    ds_write_b64 v21, v[30:31]
    ds_read_b64_tr_b16 v[232:233], v17 offset:64
    ds_read_b64_tr_b16 v[234:235], v17 offset:16960
    ds_read_b64_tr_b16 v[236:237], v17 offset:33856
    ds_read_b64_tr_b16 v[238:239], v17 offset:50752
    ds_read_b64_tr_b16 v[240:241], v16 offset:96
    ds_read_b64_tr_b16 v[242:243], v16 offset:16992
    ds_read_b64_tr_b16 v[244:245], v16 offset:33888
    ds_read_b64_tr_b16 v[246:247], v16 offset:50784
    ds_read_b64_tr_b16 v[248:249], v17 offset:96
    ds_read_b64_tr_b16 v[250:251], v17 offset:16992
    ds_read_b64_tr_b16 v[252:253], v17 offset:33888
    ds_read_b64_tr_b16 v[254:255], v17 offset:50784
    v_add_f32 v64, v64, v65
    v_add_f32 v66, v66, v67
    v_fma_f32 v92, v92, v88, v64
    v_add_f32 v92, v92, v66
    v_pk_mul_f32 v[96:97], v[96:97], v[88:89] op_sel_hi:[1,0]
    v_pk_mul_f32 v[98:99], v[98:99], v[88:89] op_sel_hi:[1,0]
    v_pk_mul_f32 v[100:101], v[100:101], v[88:89] op_sel_hi:[1,0]
    v_pk_mul_f32 v[102:103], v[102:103], v[88:89] op_sel_hi:[1,0]
    v_pk_mul_f32 v[104:105], v[104:105], v[88:89] op_sel_hi:[1,0]
    v_pk_mul_f32 v[106:107], v[106:107], v[88:89] op_sel_hi:[1,0]
    v_pk_mul_f32 v[108:109], v[108:109], v[88:89] op_sel_hi:[1,0]
    v_pk_mul_f32 v[110:111], v[110:111], v[88:89] op_sel_hi:[1,0]
    s_waitcnt vmcnt(0) lgkmcnt(0)
    s_barrier
    ds_read_b128 v[72:75], v22 offset:0
    ds_read_b128 v[76:79], v22 offset:1024
    ds_read_b128 v[80:83], v22 offset:2048
    ds_read_b128 v[84:87], v22 offset:3072
    s_add_u32 m0, s62, 0
    s_add_u32 s56, s61, 393216
    buffer_load_dwordx4 v26, s[36:39], s56 offen  lds
    s_add_u32 m0, m0, 1056
    s_addk_i32 s56, 1024
    buffer_load_dwordx4 v26, s[36:39], s56 offen  lds
    s_add_u32 m0, m0, 1056
    s_addk_i32 s56, 1024
    buffer_load_dwordx4 v26, s[36:39], s56 offen  lds
    s_add_u32 m0, m0, 1056
    s_addk_i32 s56, 1024
    buffer_load_dwordx4 v26, s[36:39], s56 offen  lds
    s_add_u32 m0, m0, 1056
    s_addk_i32 s56, 1024
    buffer_load_dwordx4 v26, s[36:39], s56 offen  lds
    s_add_u32 m0, m0, 1056
    s_addk_i32 s56, 1024
    buffer_load_dwordx4 v26, s[36:39], s56 offen  lds
    s_add_u32 m0, m0, 1056
    s_addk_i32 s56, 1024
    buffer_load_dwordx4 v26, s[36:39], s56 offen  lds
    s_add_u32 m0, m0, 1056
    s_addk_i32 s56, 1024
    buffer_load_dwordx4 v26, s[36:39], s56 offen  lds
    ds_write_b128 v28, v[32:35] offset:0
    ds_write_b128 v28, v[36:39] offset:1056
    ds_write_b128 v28, v[40:43] offset:2112
    ds_write_b128 v28, v[44:47] offset:3168
    ds_write_b128 v28, v[48:51] offset:4224
    ds_write_b128 v28, v[52:55] offset:5280
    ds_write_b128 v28, v[56:59] offset:6336
    ds_write_b128 v28, v[60:63] offset:7392
    s_waitcnt lgkmcnt(11)
    v_mfma_f32_16x16x32_bf16 v[96:99], v[192:195], v[72:75], v[96:99]
    v_mfma_f32_16x16x32_bf16 v[100:103], v[208:211], v[72:75], v[100:103]
    v_mfma_f32_16x16x32_bf16 v[104:107], v[224:227], v[72:75], v[104:107]
    v_mfma_f32_16x16x32_bf16 v[108:111], v[240:243], v[72:75], v[108:111]
    s_waitcnt lgkmcnt(10)
    v_mfma_f32_16x16x32_bf16 v[96:99], v[196:199], v[76:79], v[96:99]
    v_mfma_f32_16x16x32_bf16 v[100:103], v[212:215], v[76:79], v[100:103]
    v_mfma_f32_16x16x32_bf16 v[104:107], v[228:231], v[76:79], v[104:107]
    v_mfma_f32_16x16x32_bf16 v[108:111], v[244:247], v[76:79], v[108:111]
    s_waitcnt lgkmcnt(9)
    v_mfma_f32_16x16x32_bf16 v[96:99], v[200:203], v[80:83], v[96:99]
    v_mfma_f32_16x16x32_bf16 v[100:103], v[216:219], v[80:83], v[100:103]
    v_mfma_f32_16x16x32_bf16 v[104:107], v[232:235], v[80:83], v[104:107]
    v_mfma_f32_16x16x32_bf16 v[108:111], v[248:251], v[80:83], v[108:111]
    s_waitcnt lgkmcnt(8)
    v_mfma_f32_16x16x32_bf16 v[96:99], v[204:207], v[84:87], v[96:99]
    v_mfma_f32_16x16x32_bf16 v[100:103], v[220:223], v[84:87], v[100:103]
    v_mfma_f32_16x16x32_bf16 v[104:107], v[236:239], v[84:87], v[104:107]
    v_mfma_f32_16x16x32_bf16 v[108:111], v[252:255], v[84:87], v[108:111]
    s_waitcnt lgkmcnt(0)
    s_waitcnt vmcnt(0)
    s_barrier
    ds_read_b128 v[192:195], v14 offset:0
    ds_read_b128 v[196:199], v14 offset:64
    ds_read_b128 v[200:203], v14 offset:128
    ds_read_b128 v[204:207], v14 offset:192
    ds_read_b128 v[208:211], v14 offset:256
    ds_read_b128 v[212:215], v14 offset:320
    ds_read_b128 v[216:219], v14 offset:384
    ds_read_b128 v[220:223], v14 offset:448
    s_waitcnt lgkmcnt(7)
    v_mfma_f32_16x16x32_bf16 v[64:67], v[192:195], v[128:131], 0
    ds_read_b128 v[224:227], v14 offset:512
    s_waitcnt lgkmcnt(7)
    v_mfma_f32_16x16x32_bf16 v[64:67], v[196:199], v[132:135], v[64:67]
    ds_read_b128 v[228:231], v14 offset:576
    s_waitcnt lgkmcnt(7)
    v_mfma_f32_16x16x32_bf16 v[64:67], v[200:203], v[136:139], v[64:67]
    ds_read_b128 v[232:235], v14 offset:640
    s_waitcnt lgkmcnt(7)
    v_mfma_f32_16x16x32_bf16 v[64:67], v[204:207], v[140:143], v[64:67]
    ds_read_b128 v[236:239], v14 offset:704
    s_waitcnt lgkmcnt(7)
    v_mfma_f32_16x16x32_bf16 v[64:67], v[208:211], v[144:147], v[64:67]
    ds_read_b128 v[240:243], v14 offset:768
    s_waitcnt lgkmcnt(7)
    v_mfma_f32_16x16x32_bf16 v[64:67], v[212:215], v[148:151], v[64:67]
    ds_read_b128 v[244:247], v14 offset:832
    s_waitcnt lgkmcnt(7)
    v_mfma_f32_16x16x32_bf16 v[64:67], v[216:219], v[152:155], v[64:67]
    ds_read_b128 v[248:251], v14 offset:896
    s_waitcnt lgkmcnt(7)
    v_mfma_f32_16x16x32_bf16 v[64:67], v[220:223], v[156:159], v[64:67]
    ds_read_b128 v[252:255], v14 offset:960
    s_waitcnt lgkmcnt(7)
    v_mfma_f32_16x16x32_bf16 v[64:67], v[224:227], v[160:163], v[64:67]
    s_waitcnt lgkmcnt(6)
    v_mfma_f32_16x16x32_bf16 v[64:67], v[228:231], v[164:167], v[64:67]
    s_waitcnt lgkmcnt(5)
    v_mfma_f32_16x16x32_bf16 v[64:67], v[232:235], v[168:171], v[64:67]
    s_waitcnt lgkmcnt(4)
    v_mfma_f32_16x16x32_bf16 v[64:67], v[236:239], v[172:175], v[64:67]
    s_waitcnt lgkmcnt(3)
    v_mfma_f32_16x16x32_bf16 v[64:67], v[240:243], v[176:179], v[64:67]
    s_waitcnt lgkmcnt(2)
    v_mfma_f32_16x16x32_bf16 v[64:67], v[244:247], v[180:183], v[64:67]
    s_waitcnt lgkmcnt(1)
    v_mfma_f32_16x16x32_bf16 v[64:67], v[248:251], v[184:187], v[64:67]
    s_waitcnt lgkmcnt(0)
    v_mfma_f32_16x16x32_bf16 v[64:67], v[252:255], v[188:191], v[64:67]
    ds_read_b64_tr_b16 v[192:193], v16 offset:0
    ds_read_b64_tr_b16 v[194:195], v16 offset:16896
    ds_read_b64_tr_b16 v[196:197], v16 offset:33792
    ds_read_b64_tr_b16 v[198:199], v16 offset:50688
    ds_read_b64_tr_b16 v[200:201], v17 offset:0
    ds_read_b64_tr_b16 v[202:203], v17 offset:16896
    ds_read_b64_tr_b16 v[204:205], v17 offset:33792
    ds_read_b64_tr_b16 v[206:207], v17 offset:50688
    v_max3_f32 v24, v64, v65, v66
    v_max_f32 v24, v24, v67
    v_mov_b32 v30, v24
    s_nop 1
    v_permlane32_swap_b32 v24, v30
    v_max_f32 v24, v24, v30
    v_mov_b32 v30, v24
    s_nop 1
    v_permlane16_swap_b32 v24, v30
    v_max_f32 v24, v24, v30
    s_mov_b64 exec, 0xffff
    ds_write_b32 v18, v24
    s_mov_b64 exec, -1
    s_waitcnt lgkmcnt(0)
    s_barrier
    ds_read_b128 v[72:75], v19
    ds_read_b128 v[76:79], v19 offset:16
    ds_read_b64_tr_b16 v[208:209], v16 offset:32
    ds_read_b64_tr_b16 v[210:211], v16 offset:16928
    ds_read_b64_tr_b16 v[212:213], v16 offset:33824
    ds_read_b64_tr_b16 v[214:215], v16 offset:50720
    ds_read_b64_tr_b16 v[216:217], v17 offset:32
    ds_read_b64_tr_b16 v[218:219], v17 offset:16928
    ds_read_b64_tr_b16 v[220:221], v17 offset:33824
    ds_read_b64_tr_b16 v[222:223], v17 offset:50720
    ds_read_b64_tr_b16 v[224:225], v16 offset:64
    ds_read_b64_tr_b16 v[226:227], v16 offset:16960
    ds_read_b64_tr_b16 v[228:229], v16 offset:33856
    ds_read_b64_tr_b16 v[230:231], v16 offset:50752
    s_waitcnt lgkmcnt(12)
    v_max3_f32 v72, v72, v73, v74
    v_max3_f32 v75, v75, v76, v77
    v_max3_f32 v72, v72, v78, v79
    v_max3_f32 v72, v72, v75, v68
    v_sub_f32 v88, v68, v72
    v_mov_b32 v68, v72
    v_mul_f32 v88, s60, v88
    v_exp_f32 v88, v88
    v_mul_f32 v24, s60, v68
    v_fma_f32 v64, v64, s60, -v24
    v_fma_f32 v65, v65, s60, -v24
    v_fma_f32 v66, v66, s60, -v24
    v_fma_f32 v67, v67, s60, -v24
    v_exp_f32 v64, v64
    v_exp_f32 v65, v65
    v_exp_f32 v66, v66
    v_exp_f32 v67, v67
    v_cvt_pk_bf16_f32 v30, v64, v65
    v_cvt_pk_bf16_f32 v31, v66, v67
    ds_write_b64 v21, v[30:31]
    ds_read_b64_tr_b16 v[232:233], v17 offset:64
    ds_read_b64_tr_b16 v[234:235], v17 offset:16960
    ds_read_b64_tr_b16 v[236:237], v17 offset:33856
    ds_read_b64_tr_b16 v[238:239], v17 offset:50752
    ds_read_b64_tr_b16 v[240:241], v16 offset:96
    ds_read_b64_tr_b16 v[242:243], v16 offset:16992
    ds_read_b64_tr_b16 v[244:245], v16 offset:33888
    ds_read_b64_tr_b16 v[246:247], v16 offset:50784
    ds_read_b64_tr_b16 v[248:249], v17 offset:96
    ds_read_b64_tr_b16 v[250:251], v17 offset:16992
    ds_read_b64_tr_b16 v[252:253], v17 offset:33888
    ds_read_b64_tr_b16 v[254:255], v17 offset:50784
    v_add_f32 v64, v64, v65
    v_add_f32 v66, v66, v67
    v_fma_f32 v92, v92, v88, v64
    v_add_f32 v92, v92, v66
    v_pk_mul_f32 v[96:97], v[96:97], v[88:89] op_sel_hi:[1,0]
    v_pk_mul_f32 v[98:99], v[98:99], v[88:89] op_sel_hi:[1,0]
    v_pk_mul_f32 v[100:101], v[100:101], v[88:89] op_sel_hi:[1,0]
    v_pk_mul_f32 v[102:103], v[102:103], v[88:89] op_sel_hi:[1,0]
    v_pk_mul_f32 v[104:105], v[104:105], v[88:89] op_sel_hi:[1,0]
    v_pk_mul_f32 v[106:107], v[106:107], v[88:89] op_sel_hi:[1,0]
    v_pk_mul_f32 v[108:109], v[108:109], v[88:89] op_sel_hi:[1,0]
    v_pk_mul_f32 v[110:111], v[110:111], v[88:89] op_sel_hi:[1,0]
    s_waitcnt vmcnt(0) lgkmcnt(0)
    s_barrier
    ds_read_b128 v[72:75], v22 offset:0
    ds_read_b128 v[76:79], v22 offset:1024
    ds_read_b128 v[80:83], v22 offset:2048
    ds_read_b128 v[84:87], v22 offset:3072
    s_waitcnt lgkmcnt(3)
    v_mfma_f32_16x16x32_bf16 v[96:99], v[192:195], v[72:75], v[96:99]
    v_mfma_f32_16x16x32_bf16 v[100:103], v[208:211], v[72:75], v[100:103]
    v_mfma_f32_16x16x32_bf16 v[104:107], v[224:227], v[72:75], v[104:107]
    v_mfma_f32_16x16x32_bf16 v[108:111], v[240:243], v[72:75], v[108:111]
    s_waitcnt lgkmcnt(2)
    v_mfma_f32_16x16x32_bf16 v[96:99], v[196:199], v[76:79], v[96:99]
    v_mfma_f32_16x16x32_bf16 v[100:103], v[212:215], v[76:79], v[100:103]
    v_mfma_f32_16x16x32_bf16 v[104:107], v[228:231], v[76:79], v[104:107]
    v_mfma_f32_16x16x32_bf16 v[108:111], v[244:247], v[76:79], v[108:111]
    s_waitcnt lgkmcnt(1)
    v_mfma_f32_16x16x32_bf16 v[96:99], v[200:203], v[80:83], v[96:99]
    v_mfma_f32_16x16x32_bf16 v[100:103], v[216:219], v[80:83], v[100:103]
    v_mfma_f32_16x16x32_bf16 v[104:107], v[232:235], v[80:83], v[104:107]
    v_mfma_f32_16x16x32_bf16 v[108:111], v[248:251], v[80:83], v[108:111]
    s_waitcnt lgkmcnt(0)
    v_mfma_f32_16x16x32_bf16 v[96:99], v[204:207], v[84:87], v[96:99]
    v_mfma_f32_16x16x32_bf16 v[100:103], v[220:223], v[84:87], v[100:103]
    v_mfma_f32_16x16x32_bf16 v[104:107], v[236:239], v[84:87], v[104:107]
    v_mfma_f32_16x16x32_bf16 v[108:111], v[252:255], v[84:87], v[108:111]
    v_mov_b32 v24, v92
    s_nop 1
    v_permlane32_swap_b32 v92, v24
    v_add_f32 v92, v92, v24
    v_mov_b32 v24, v92
    s_nop 1
    v_permlane16_swap_b32 v92, v24
    v_add_f32 v92, v92, v24
    s_movk_i32 s59, 1056
    v_mul_lo_u32 v24, v11, s59
    v_lshl_add_u32 v24, v12, 3, v24
    s_lshl_b32 s56, s3, 7
    v_add_u32 v14, s56, v24
    s_mov_b64 exec, 0xffff
    ds_write_b32 v18, v92 offset:1024
    s_mov_b64 exec, -1
    v_cvt_pk_bf16_f32 v40, v96, v97
    v_cvt_pk_bf16_f32 v41, v98, v99
    ds_write_b64 v14, v[40:41] offset:0
    v_cvt_pk_bf16_f32 v42, v100, v101
    v_cvt_pk_bf16_f32 v43, v102, v103
    ds_write_b64 v14, v[42:43] offset:32
    v_cvt_pk_bf16_f32 v44, v104, v105
    v_cvt_pk_bf16_f32 v45, v106, v107
    ds_write_b64 v14, v[44:45] offset:64
    v_cvt_pk_bf16_f32 v46, v108, v109
    v_cvt_pk_bf16_f32 v47, v110, v111
    ds_write_b64 v14, v[46:47] offset:96
    s_mul_i32 s56, s3, 2112
    v_add_u32 v13, s56, v26
    s_lshl_b32 s57, s66, 15
    s_lshl_b32 s56, s67, 14
    s_add_u32 s57, s57, s56
    s_lshl_b32 s56, s3, 11
    s_add_u32 s57, s57, s56
    s_add_u32 s57, s57, 1048576
    s_waitcnt lgkmcnt(0)
    s_barrier
    ds_read_b128 v[40:43], v13 offset:0
    ds_read_b128 v[44:47], v13 offset:1056
    s_waitcnt lgkmcnt(1)
    buffer_store_dwordx4 v[40:43], v26, s[44:47], s57 offen offset:0 sc1
    s_waitcnt lgkmcnt(0)
    buffer_store_dwordx4 v[44:47], v26, s[44:47], s57 offen offset:1024 sc1
    s_lshl_b32 s56, s67, 12
    v_lshl_add_u32 v24, v11, 8, s56
    s_cmp_eq_u32 s3, 7
    s_cbranch_scc0 L_acu_noml
    ds_read_b128 v[56:59], v19 offset:1024
    ds_read_b128 v[60:63], v19 offset:1040
    v_mov_b32 v20, v68
    s_lshl_b32 s56, s66, 3
    s_add_u32 s56, s56, 16384
    s_waitcnt lgkmcnt(0)
    v_pk_add_f32 v[56:57], v[56:57], v[58:59]
    v_pk_add_f32 v[60:61], v[60:61], v[62:63]
    v_pk_add_f32 v[56:57], v[56:57], v[60:61]
    v_add_f32 v21, v56, v57
    s_mov_b64 exec, 0xffff
    buffer_store_dwordx2 v[20:21], v24, s[44:47], s56 offen sc1
    s_mov_b64 exec, -1
L_acu_noml:
    s_waitcnt vmcnt(0)
    s_barrier
    s_cmp_lt_u32 s3, 4
    s_cbranch_scc1 L_acu_stream
    s_cmp_eq_u32 s3, 6
    s_cbranch_scc1 L_s2
    s_setprio 3
    s_cmp_eq_u32 s3, 7
    s_cbranch_scc0 L_wtail2
    v_mov_b32 v22, 1
    s_movk_i32 s56, 8192
    s_mov_b64 exec, 0xffff
    buffer_atomic_add v22, v24, s[44:47], s56 offen sc1
    s_mov_b64 exec, -1
    s_branch L_idle
L_acu_stream:
    s_lshl_b32 s72, s32, 21
    s_lshl_b32 s56, s3, 12
    s_add_u32 s72, s72, s56
    s_mul_i32 s56, s32, 1
    s_and_b32 s56, s56, 15
    s_lshl_b32 s56, s56, 17
    s_add_u32 s72, s72, s56
    v_lshl_add_u32 v9, v9, 8, v10
    s_mov_b32 s36, s18
    s_mov_b32 s37, s19
    s_mov_b32 s38, 0x4000000
    s_mov_b32 s39, 0x20000
    s_mov_b32 s40, s20
    s_mov_b32 s41, s21
    s_mov_b32 s42, 0x4000000
    s_mov_b32 s43, 0x20000
    v_and_b32 v13, 1, v0
    v_cmp_eq_u32 vcc, 1, v13
    v_mov_b32 v14, 0xc0c0100
    v_mov_b32 v1, 0x1000c0c
    v_cndmask_b32 v14, v14, v1, vcc
    v_mov_b32 v15, 0xc0c0302
    v_mov_b32 v1, 0x3020c0c
    v_cndmask_b32 v15, v15, v1, vcc
    v_bfe_u32 v13, v0, 1, 2
    v_cmp_eq_u32 vcc, 0, v13
    v_mov_b32 v1, 0x0c0c0c0c
    v_mov_b32 v2, 0x0c0c0c0c
    v_cndmask_b32 v1, v1, v14, vcc
    v_cndmask_b32 v2, v2, v15, vcc
    v_cmp_eq_u32 vcc, 1, v13
    v_mov_b32 v3, 0x0c0c0c0c
    v_mov_b32 v4, 0x0c0c0c0c
    v_cndmask_b32 v3, v3, v14, vcc
    v_cndmask_b32 v4, v4, v15, vcc
    v_cmp_eq_u32 vcc, 2, v13
    v_mov_b32 v5, 0x0c0c0c0c
    v_mov_b32 v6, 0x0c0c0c0c
    v_cndmask_b32 v5, v5, v14, vcc
    v_cndmask_b32 v6, v6, v15, vcc
    v_cmp_eq_u32 vcc, 3, v13
    v_mov_b32 v7, 0x0c0c0c0c
    v_mov_b32 v8, 0x0c0c0c0c
    v_cndmask_b32 v7, v7, v14, vcc
    v_cndmask_b32 v8, v8, v15, vcc
    v_mov_b32 v28, 0
    v_mov_b32 v29, 0
    v_mov_b32 v30, 0
    v_mov_b32 v31, 0
    v_mov_b32 v36, 0xff61b1e6
    v_mov_b32 v37, 0
    v_add_u32 v11, 135168, v10
    s_lshl_b32 s56, s3, 9
    s_add_u32 s56, s56, 140288
    v_add_u32 v16, s56, v26
    s_lshl_b32 s56, s3, 3
    s_add_u32 s56, s56, 139520
    v_mov_b32 v17, s56
    v_add_u32 v19, 64, v25
    v_mov_b32 v20, 1
    s_mov_b64 exec, 1
    ds_add_u32 v25, v20 offset:16
    s_mov_b64 exec, -1
    s_mov_b32 s63, 0
L_flag29:
    ds_read_b32 v39, v25 offset:0
    s_add_u32 s63, s63, 1
    s_waitcnt lgkmcnt(0)
    v_cmp_gt_u32 vcc, 1, v39
    s_cbranch_vccz L_flag29_ok
    s_sleep 1
    s_cmp_lt_u32 s63, 2000000
    s_cbranch_scc1 L_flag29
L_flag29_ok:
    ds_read_b128 v[12:15], v11
    s_waitcnt lgkmcnt(0)
    s_mov_b32 s63, 0
L_take30:
    ds_read_b32 v39, v19
    s_add_u32 s63, s63, 1
    s_waitcnt lgkmcnt(0)
    v_readfirstlane_b32 s71, v39
    s_cmp_lt_u32 s63, 2000000
    s_cselect_b32 s71, s71, -1
    s_cmp_eq_u32 s71, 0
    s_cbranch_scc1 L_take30
    s_cmp_lt_u32 s71, 128
    s_cbranch_scc0 L_none
    v_add_u32 v19, 4, v19
    s_lshl_b32 s56, s71, 14
    s_xor_b32 s61, s56, s72
    s_mov_b64 exec, 1
    ds_add_u32 v25, v20 offset:16
    s_mov_b64 exec, -1
    buffer_load_dwordx4 v[128:131], v9, s[36:39], s61 offen offset:0 nt
    buffer_load_dwordx4 v[132:135], v9, s[36:39], s61 offen offset:1024 nt
    buffer_load_dwordx4 v[136:139], v9, s[36:39], s61 offen offset:2048 nt
    buffer_load_dwordx4 v[140:143], v9, s[36:39], s61 offen offset:3072 nt
    buffer_load_dwordx4 v[144:147], v26, s[40:43], s61 offen offset:0 nt
    buffer_load_dwordx4 v[148:151], v26, s[40:43], s61 offen offset:1024 nt
    s_branch L_loop
L_idle:
    s_lshl_b32 s56, s33, 14
    s_lshl_b32 s57, s32, 8
    s_add_u32 s56, s56, s57
    s_add_u32 s56, s56, 786432
    s_add_u32 s80, s30, s56
    s_addc_u32 s81, s31, 0
    s_mov_b32 s57, -1
    s_mov_b32 s58, -1
    s_mov_b32 s63, 0
L_probe:
    s_memtime s[68:69]
    s_waitcnt lgkmcnt(0)
    s_load_dword s56, s[80:81], 0 glc
    s_waitcnt lgkmcnt(0)
    s_memtime s[70:71]
    s_waitcnt lgkmcnt(0)
    s_sub_u32 s56, s70, s68
    s_min_u32 s57, s57, s56
    s_memtime s[68:69]
    s_waitcnt lgkmcnt(0)
    s_load_dword s56, s[80:81], 8192 glc
    s_waitcnt lgkmcnt(0)
    s_memtime s[70:71]
    s_waitcnt lgkmcnt(0)
    s_sub_u32 s56, s70, s68
    s_min_u32 s58, s58, s56
    s_cmp_lt_u32 s57, s58
    s_cselect_b32 s56, 0, 8192
    v_mov_b32 v24, s56
    ds_write_b32 v25, v24 offset:12
    s_add_u32 s63, s63, 1
    s_cmp_lt_u32 s63, 4
    s_cbranch_scc1 L_probe
    s_mov_b32 s44, s30
    s_mov_b32 s45, s31
    s_mov_b32 s46, 0x200000
    s_mov_b32 s47, 0x20000
    v_and_b32 v24, 1, v0
    v_cmp_eq_u32 vcc, 1, v24
    v_mov_b32 v28, 0xc0c0100
    v_mov_b32 v1, 0x1000c0c
    v_cndmask_b32 v28, v28, v1, vcc
    v_mov_b32 v29, 0xc0c0302
    v_mov_b32 v1, 0x3020c0c
    v_cndmask_b32 v29, v29, v1, vcc
    v_bfe_u32 v24, v0, 1, 2
    v_cmp_eq_u32 vcc, 0, v24
    v_mov_b32 v1, 0x0c0c0c0c
    v_mov_b32 v2, 0x0c0c0c0c
    v_cndmask_b32 v1, v1, v28, vcc
    v_cndmask_b32 v2, v2, v29, vcc
    v_cmp_eq_u32 vcc, 1, v24
    v_mov_b32 v3, 0x0c0c0c0c
    v_mov_b32 v4, 0x0c0c0c0c
    v_cndmask_b32 v3, v3, v28, vcc
    v_cndmask_b32 v4, v4, v29, vcc
    v_cmp_eq_u32 vcc, 2, v24
    v_mov_b32 v5, 0x0c0c0c0c
    v_mov_b32 v6, 0x0c0c0c0c
    v_cndmask_b32 v5, v5, v28, vcc
    v_cndmask_b32 v6, v6, v29, vcc
    v_cmp_eq_u32 vcc, 3, v24
    v_mov_b32 v7, 0x0c0c0c0c
    v_mov_b32 v8, 0x0c0c0c0c
    v_cndmask_b32 v7, v7, v28, vcc
    v_cndmask_b32 v8, v8, v29, vcc
    v_lshlrev_b32 v27, 4, v11
    v_bfe_u32 v24, v0, 4, 1
    v_lshl_add_u32 v27, v24, 3, v27
    v_lshrrev_b32 v24, 5, v0
    v_lshl_add_u32 v27, v24, 2, v27
    s_mov_b32 s8, 0x07060501
    s_mov_b32 s9, 0x07060502
    s_mov_b32 s10, 0x07060503
    s_mov_b32 s11, 0x0c04000c
    s_mov_b32 s63, 0
L_flag31:
    ds_read_b32 v24, v25 offset:24
    s_add_u32 s63, s63, 1
    s_waitcnt lgkmcnt(0)
    v_cmp_gt_u32 vcc, 1, v24
    s_cbranch_vccz L_flag31_ok
    s_sleep 8
    s_cmp_lt_u32 s63, 2000000
    s_cbranch_scc1 L_flag31
L_flag31_ok:
    ds_read_b32 v24, v25 offset:44
    s_lshl_b32 s57, s32, 11
    s_add_u32 s57, s57, 262144
    s_waitcnt lgkmcnt(0)
    v_readfirstlane_b32 s34, v24
    s_mov_b32 s63, 0
L_flag32:
    ds_read_b32 v24, v25 offset:32
    s_add_u32 s63, s63, 1
    s_waitcnt lgkmcnt(0)
    v_cmp_gt_u32 vcc, 1, v24
    s_cbranch_vccz L_flag32_ok
    s_sleep 2
    s_cmp_lt_u32 s63, 2000000
    s_cbranch_scc1 L_flag32
L_flag32_ok:
    v_readfirstlane_b32 s56, v24
    s_nop 0
    s_and_b32 s56, s56, 7
    s_lshl_b32 s56, s56, 2
    s_lshr_b32 s56, 0x32108888, s56
    s_and_b32 s56, s56, 15
    s_cmp_eq_u32 s56, 8
    s_cbranch_scc1 L_fin
    s_mov_b32 s63, 0
    buffer_load_dwordx4 v[56:59], v26, s[44:47], s57 offen offset:0 sc1
    buffer_load_dwordx4 v[60:63], v26, s[44:47], s57 offen offset:1024 sc1
L_poll33:
    s_waitcnt vmcnt(0)
    v_cmp_ne_u32 s[68:69], s34, v59
    v_cmp_ne_u32 s[70:71], s34, v63
    s_nop 0
    s_or_b64 vcc, s[68:69], s[70:71]
    s_cbranch_scc0 L_poll33_ok
    s_mov_b64 exec, s[68:69]
    buffer_load_dwordx4 v[56:59], v26, s[44:47], s57 offen offset:0 sc1
    s_mov_b64 exec, s[70:71]
    buffer_load_dwordx4 v[60:63], v26, s[44:47], s57 offen offset:1024 sc1
    s_mov_b64 exec, -1
    s_add_u32 s63, s63, 1
    s_cmp_lt_u32 s63, 200000
    s_cbranch_scc1 L_poll33
    s_waitcnt vmcnt(0)
L_poll33_ok:
    v_perm_b32 v59, v57, v56, s11
    v_perm_b32 v63, v61, v60, s11
    v_lshl_or_b32 v59, v58, 24, v59
    v_lshl_or_b32 v63, v62, 24, v63
    v_add_f32 v56, v56, v60
    v_add_f32 v57, v57, v61
    v_add_f32 v58, v58, v62
    v_add_f32 v59, v59, v63
    v_add_u32 v15, 135936, v27
    v_permlane32_swap_b32 v56, v58
    v_permlane32_swap_b32 v57, v59
    v_add_f32 v32, v56, v58
    v_add_f32 v33, v57, v59
    v_cvt_pk_bf16_f32 v24, v32, v33
    ds_write_b32 v15, v24
    v_mov_b32 v24, 1
    s_mov_b64 exec, 1
    ds_add_u32 v25, v24 offset:40
    s_mov_b64 exec, -1
L_fin:
L_end:
    s_endpgm
L_codeend:
.section .rodata,"a"
.p2align 6
.amdhsa_kernel concat_heads__compressed_kv_cla__mha_block_cached__decode_kernel
  .amdhsa_next_free_vgpr 256
  .amdhsa_next_free_sgpr 102
  .amdhsa_accum_offset 256
  .amdhsa_group_segment_fixed_size 0
  .amdhsa_kernarg_size 112
  .amdhsa_user_sgpr_count 2
  .amdhsa_user_sgpr_kernarg_segment_ptr 1
  .amdhsa_system_sgpr_workgroup_id_x 1
.end_amdhsa_kernel
```
